```python
import torch

def _softmax(x, axis=-1):
    return torch.softmax(x, dim=axis)
def _gelu(x):
    return torch.nn.functional.gelu(x, approximate="tanh")
def _silu(x):
    return torch.nn.functional.silu(x)
def _sigmoid(x):
    return torch.sigmoid(x)
def _layernorm(x, axis=-1, eps=1e-5):
    m = x.mean(dim=axis, keepdim=True)
    v = x.var(dim=axis, keepdim=True, unbiased=False)
    return (x - m) / torch.sqrt(v + eps)
def _scatter_add(tgt, idx, src, axis=0):
    return tgt.clone().index_add_(axis, idx, src)
def _segment_sum(src, seg, n):
    out = torch.zeros((n,) + src.shape[1:], dtype=src.dtype)
    return out.index_add_(0, seg, src)
def _pad(x, pw):
    flat = tuple(v for pair in reversed(pw) for v in pair)
    return torch.nn.functional.pad(x, flat)

kernel_name = 'interleave_layers__grouped_kv_mqa__sliding_local_dilated__prompt'

def setup_inputs():

    _w = (lambda a: (lambda t: t.to(torch.bfloat16) if t.is_floating_point() else t)(torch.as_tensor(a)))
    def _A_setup():
        B, S, D, H = 1, 2048, 576, 32
        Dh = D // H
        return {
            "x": _w((lambda *s: torch.randn(*s, dtype=torch.bfloat16) * 0.05)(B, S, D)),
            "wq": _w((lambda *s: torch.randn(*s, dtype=torch.bfloat16) * 0.05)(D, H * Dh)),
            "wk": _w((lambda *s: torch.randn(*s, dtype=torch.bfloat16) * 0.05)(D, Dh)),
            "wv": _w((lambda *s: torch.randn(*s, dtype=torch.bfloat16) * 0.05)(D, Dh)),
            "wo": _w((lambda *s: torch.randn(*s, dtype=torch.bfloat16) * 0.05)(H * Dh, D)),
        }
    _A_in = _A_setup()

    def _B_setup():
        B, S, D = 1, 2048, 576
        return {
            "x": _w((lambda *s: torch.randn(*s, dtype=torch.bfloat16) * 0.05)(B, S, D)),
            "wqkv": _w((lambda *s: torch.randn(*s, dtype=torch.bfloat16) * 0.05)(D, 3 * D)),
            "wo": _w((lambda *s: torch.randn(*s, dtype=torch.bfloat16) * 0.05)(D, D)),
        }
    _B_in = _B_setup()

    return {
        "A_x": _A_in["x"],
        "A_wq": _A_in["wq"],
        "A_wk": _A_in["wk"],
        "A_wv": _A_in["wv"],
        "A_wo": _A_in["wo"],
        "B_x": _B_in["x"],
        "B_wqkv": _B_in["wqkv"],
        "B_wo": _B_in["wo"],
    }

def reference(A_x, A_wq, A_wk, A_wv, A_wo, B_x, B_wqkv, B_wo):
    def _A_ref(x, wq, wk, wv, wo):
        B, S, D = x.shape
        H = 32
        Dh = D // H
        q = (lambda x, *d: x.permute(*d))((x @ wq).reshape(B, S, H, Dh), 0, 2, 1, 3)
        k = x @ wk
        v = x @ wv
        scores = torch.einsum("bhqd,bkd->bhqk", q, k) * (Dh ** -0.5)
        p = _softmax(scores, axis=-1)
        o = torch.einsum("bhqk,bkd->bhqd", p, v)
        return (lambda x, *d: x.permute(*d))(o, 0, 2, 1, 3).reshape(B, S, H * Dh) @ wo

    def _B_ref(x, wqkv, wo):
        B, S, D = x.shape
        H = 32; Dh = D // H
        W, dil = 8, 2
        qkv = (lambda x, *d: x.permute(*d))((x @ wqkv).reshape(B, S, 3, H, Dh), 2, 0, 3, 1, 4)
        q, k, v = qkv[0], qkv[1], qkv[2]
        scale = Dh ** -0.5
        pos = torch.arange(S)
        off = torch.arange(W) * dil
        idx = pos[:, None] - off[None, :]
        mask = idx >= 0
        idx_c = torch.where(mask, idx, 0).reshape(-1)
        kg = k[:, :, idx_c, :].reshape(B, H, S, W, Dh)
        vg = v[:, :, idx_c, :].reshape(B, H, S, W, Dh)
        logits = torch.einsum("bhsd,bhswd->bhsw", q, kg) * scale
        logits = torch.where(mask[None, None, :, :], logits, -1e9)
        attn = _softmax(logits, axis=-1)
        o = torch.einsum("bhsw,bhswd->bhsd", attn, vg)
        return (lambda x, *d: x.permute(*d))(o, 0, 2, 1, 3).reshape(B, S, D) @ wo

    x = A_x
    x = x + _A_ref(_layernorm(x, axis=-1), A_wq, A_wk, A_wv, A_wo)
    x = x + _B_ref(_layernorm(x, axis=-1), B_wqkv, B_wo)
    x = x + _A_ref(_layernorm(x, axis=-1), A_wq, A_wk, A_wv, A_wo)
    x = x + _B_ref(_layernorm(x, axis=-1), B_wqkv, B_wo)
    return x
```

```asm
; @launch kernel=prep_kernel grid=(206,1,1) block=(256,1,1) lds=0
; @launch kernel=qkva0_kernel grid=(256,1,1) block=(640,1,1) lds=40960
; @launch kernel=attn_kernel grid=(256,1,1) block=(512,1,1) lds=163840
; @launch kernel=oa0_kernel grid=(256,1,1) block=(576,1,1) lds=40960
; @launch kernel=qkvb0_kernel grid=(256,1,1) block=(512,1,1) lds=93184
; @launch kernel=ob0_kernel grid=(256,1,1) block=(576,1,1) lds=40960
; @launch kernel=qkva1_kernel grid=(256,1,1) block=(640,1,1) lds=40960
; @launch kernel=attn_kernel grid=(256,1,1) block=(512,1,1) lds=163840
; @launch kernel=oa1_kernel grid=(256,1,1) block=(576,1,1) lds=40960
; @launch kernel=qkvb1_kernel grid=(256,1,1) block=(512,1,1) lds=93184
; @launch kernel=ob1_kernel grid=(256,1,1) block=(576,1,1) lds=40960
.amdgcn_target "amdgcn-amd-amdhsa--gfx950"
.text
.globl prep_kernel
.type prep_kernel,@function
.p2align 8
prep_kernel:
    s_cmp_ge_u32 s2, 206
    s_cbranch_scc1 prep_end
    s_load_dwordx4 s[4:7], s[0:1], 8
    s_load_dwordx4 s[8:11], s[0:1], 24
    s_load_dwordx4 s[12:15], s[0:1], 48
    s_load_dwordx2 s[16:17], s[0:1], 80
    s_load_dwordx2 s[18:19], s[0:1], 0
    v_lshrrev_b32 v1, 6, v0
    v_and_b32 v2, 63, v0
    v_and_b32 v3, 15, v2
    v_readfirstlane_b32 s20, v1
    v_lshrrev_b32 v4, 4, v2
    s_lshl_b32 s21, s2, 2
    s_nop 2
    s_add_u32 s21, s21, s20
    s_waitcnt lgkmcnt(0)
    s_mov_b32 s36, s16
    s_mov_b32 s37, s17
    s_mov_b32 s38, 268435456
    s_mov_b32 s39, 0x00020000
    s_sub_u32 s35, s21, 696
    s_cmp_ge_u32 s21, 696
    s_cbranch_scc1 prep_stats
    s_mul_i32 s34, s21, 21846
    s_lshr_b32 s34, s34, 16
    s_mul_i32 s35, s34, 3
    s_sub_u32 s35, s21, s35
    s_mov_b32 s21, s34
    s_cmp_ge_u32 s21, 232
    s_cbranch_scc1 prep_stats
    s_cmp_lt_u32 s21, 36
    s_cbranch_scc1 prep_wq
    s_cmp_lt_u32 s21, 40
    s_cbranch_scc1 prep_wkv
    s_cmp_lt_u32 s21, 76
    s_cbranch_scc1 prep_woa
    s_cmp_lt_u32 s21, 112
    s_cbranch_scc1 prep_wob
    s_sub_u32 s22, s21, 112
    s_mul_i32 s32, s22, 4370
    s_lshr_b32 s32, s32, 16
    s_mul_i32 s23, s32, 15
    s_sub_u32 s33, s22, s23
    s_mul_i32 s30, s22, 18432
    s_add_u32 s30, s30, 2359296
    s_lshl_b32 s31, s22, 6
    s_add_u32 s31, s31, 4657152
    s_mov_b32 s24, s12
    s_mov_b32 s25, s13
    s_mov_b32 s26, 1990656
    s_mov_b32 s27, 0x00020000
    s_mov_b32 s28, 3456
    s_lshl_b32 s23, s33, 4
    v_add_u32 v6, s23, v3
    v_mul_u32_u24 v7, 0x334, v6
    v_lshrrev_b32 v7, 16, v7
    v_mul_u32_u24 v8, 80, v7
    v_sub_u32 v8, v6, v8
    v_mul_u32_u24 v9, 0xccd, v8
    v_lshrrev_b32 v9, 16, v9
    v_mul_u32_u24 v10, 20, v9
    v_sub_u32 v10, v8, v10
    s_mul_i32 s23, s32, 72
    v_mul_u32_u24 v11, 18, v9
    v_add_u32 v11, v11, v10
    v_add_u32 v11, s23, v11
    v_mul_u32_u24 v12, 576, v7
    v_add_u32 v11, v11, v12
    v_lshlrev_b32 v5, 1, v11
    v_mov_b32 v13, 0x7fff0000
    v_cmp_gt_u32 vcc, 18, v10
    s_nop 1
    v_cndmask_b32 v5, v13, v5, vcc
    s_branch prep_go
prep_wq:
    s_sub_u32 s22, s21, 0
    s_mul_i32 s30, s22, 18432
    s_add_u32 s30, s30, 0
    s_lshl_b32 s31, s22, 6
    s_add_u32 s31, s31, 4653056
    s_mov_b32 s24, s4
    s_mov_b32 s25, s5
    s_mov_b32 s26, 663552
    s_mov_b32 s27, 0x00020000
    s_mov_b32 s28, 1152
    s_lshl_b32 s23, s22, 4
    v_add_u32 v5, s23, v3
    v_lshlrev_b32 v5, 1, v5
    s_branch prep_go
prep_woa:
    s_sub_u32 s22, s21, 40
    s_mul_i32 s30, s22, 18432
    s_add_u32 s30, s30, 786432
    s_mov_b32 s31, -1
    s_mov_b32 s24, s10
    s_mov_b32 s25, s11
    s_mov_b32 s26, 663552
    s_mov_b32 s27, 0x00020000
    s_mov_b32 s28, 1152
    s_lshl_b32 s23, s22, 4
    v_add_u32 v5, s23, v3
    v_lshlrev_b32 v5, 1, v5
    s_branch prep_go
prep_wob:
    s_sub_u32 s22, s21, 76
    s_mul_i32 s30, s22, 18432
    s_add_u32 s30, s30, 1572864
    s_mov_b32 s31, -1
    s_mov_b32 s24, s14
    s_mov_b32 s25, s15
    s_mov_b32 s26, 663552
    s_mov_b32 s27, 0x00020000
    s_mov_b32 s28, 1152
    s_lshl_b32 s23, s22, 4
    v_add_u32 v5, s23, v3
    v_lshlrev_b32 v5, 1, v5
    s_branch prep_go
prep_wkv:
    s_sub_u32 s22, s21, 36
    s_mul_i32 s30, s21, 18432
    s_add_u32 s30, s30, 0
    s_lshl_b32 s31, s21, 6
    s_add_u32 s31, s31, 4653056
    s_cmp_lt_u32 s22, 2
    s_cselect_b32 s24, s6, s8
    s_cselect_b32 s25, s7, s9
    s_mov_b32 s26, 20736
    s_mov_b32 s27, 0x00020000
    s_mov_b32 s28, 36
    s_and_b32 s23, s22, 1
    s_lshl_b32 s23, s23, 4
    v_add_u32 v6, s23, v3
    v_lshlrev_b32 v5, 1, v6
    v_mov_b32 v13, 0x7fff0000
    v_cmp_gt_u32 vcc, 18, v6
    s_nop 1
    v_cndmask_b32 v5, v13, v5, vcc
prep_go:
    v_lshlrev_b32 v6, 3, v4
    s_mul_i32 s23, s35, 192
    v_add_u32 v6, s23, v6
    v_mul_lo_u32 v6, v6, s28
    v_add_u32 v5, v5, v6
    s_mov_b32 s40, 0
    s_lshl_b32 s29, s28, 5
    v_lshlrev_b32 v7, 4, v2
    s_mul_i32 s23, s35, 6144
    s_add_u32 s30, s30, s23
    v_add_u32 v7, s30, v7
    v_mov_b32 v8, 0
    v_mov_b32 v9, 0x3f803f80
    s_add_u32 s41, s40, s28
    s_add_u32 s42, s41, s28
    s_add_u32 s43, s42, s28
    s_add_u32 s44, s43, s28
    s_add_u32 s45, s44, s28
    s_add_u32 s46, s45, s28
    s_add_u32 s47, s46, s28
    buffer_load_ushort v16, v5, s[24:27], s40 offen
    buffer_load_ushort v17, v5, s[24:27], s41 offen
    buffer_load_ushort v18, v5, s[24:27], s42 offen
    buffer_load_ushort v19, v5, s[24:27], s43 offen
    buffer_load_ushort v20, v5, s[24:27], s44 offen
    buffer_load_ushort v21, v5, s[24:27], s45 offen
    buffer_load_ushort v22, v5, s[24:27], s46 offen
    buffer_load_ushort v23, v5, s[24:27], s47 offen
    v_add_u32 v5, s29, v5
    buffer_load_ushort v24, v5, s[24:27], s40 offen
    buffer_load_ushort v25, v5, s[24:27], s41 offen
    buffer_load_ushort v26, v5, s[24:27], s42 offen
    buffer_load_ushort v27, v5, s[24:27], s43 offen
    buffer_load_ushort v28, v5, s[24:27], s44 offen
    buffer_load_ushort v29, v5, s[24:27], s45 offen
    buffer_load_ushort v30, v5, s[24:27], s46 offen
    buffer_load_ushort v31, v5, s[24:27], s47 offen
    v_add_u32 v5, s29, v5
    buffer_load_ushort v32, v5, s[24:27], s40 offen
    buffer_load_ushort v33, v5, s[24:27], s41 offen
    buffer_load_ushort v34, v5, s[24:27], s42 offen
    buffer_load_ushort v35, v5, s[24:27], s43 offen
    buffer_load_ushort v36, v5, s[24:27], s44 offen
    buffer_load_ushort v37, v5, s[24:27], s45 offen
    buffer_load_ushort v38, v5, s[24:27], s46 offen
    buffer_load_ushort v39, v5, s[24:27], s47 offen
    v_add_u32 v5, s29, v5
    buffer_load_ushort v40, v5, s[24:27], s40 offen
    buffer_load_ushort v41, v5, s[24:27], s41 offen
    buffer_load_ushort v42, v5, s[24:27], s42 offen
    buffer_load_ushort v43, v5, s[24:27], s43 offen
    buffer_load_ushort v44, v5, s[24:27], s44 offen
    buffer_load_ushort v45, v5, s[24:27], s45 offen
    buffer_load_ushort v46, v5, s[24:27], s46 offen
    buffer_load_ushort v47, v5, s[24:27], s47 offen
    v_add_u32 v5, s29, v5
    buffer_load_ushort v48, v5, s[24:27], s40 offen
    buffer_load_ushort v49, v5, s[24:27], s41 offen
    buffer_load_ushort v50, v5, s[24:27], s42 offen
    buffer_load_ushort v51, v5, s[24:27], s43 offen
    buffer_load_ushort v52, v5, s[24:27], s44 offen
    buffer_load_ushort v53, v5, s[24:27], s45 offen
    buffer_load_ushort v54, v5, s[24:27], s46 offen
    buffer_load_ushort v55, v5, s[24:27], s47 offen
    v_add_u32 v5, s29, v5
    buffer_load_ushort v56, v5, s[24:27], s40 offen
    buffer_load_ushort v57, v5, s[24:27], s41 offen
    buffer_load_ushort v58, v5, s[24:27], s42 offen
    buffer_load_ushort v59, v5, s[24:27], s43 offen
    buffer_load_ushort v60, v5, s[24:27], s44 offen
    buffer_load_ushort v61, v5, s[24:27], s45 offen
    buffer_load_ushort v62, v5, s[24:27], s46 offen
    buffer_load_ushort v63, v5, s[24:27], s47 offen
    v_add_u32 v5, s29, v5
    s_waitcnt vmcnt(40)
    v_lshl_or_b32 v64, v17, 16, v16
    v_lshl_or_b32 v65, v19, 16, v18
    v_lshl_or_b32 v66, v21, 16, v20
    v_lshl_or_b32 v67, v23, 16, v22
    v_dot2_f32_bf16 v8, v64, v9, v8
    v_dot2_f32_bf16 v8, v65, v9, v8
    v_dot2_f32_bf16 v8, v66, v9, v8
    v_dot2_f32_bf16 v8, v67, v9, v8
    buffer_store_dwordx4 v[64:67], v7, s[36:39], 0 offen offset:0
    s_waitcnt vmcnt(32)
    v_lshl_or_b32 v68, v25, 16, v24
    v_lshl_or_b32 v69, v27, 16, v26
    v_lshl_or_b32 v70, v29, 16, v28
    v_lshl_or_b32 v71, v31, 16, v30
    v_dot2_f32_bf16 v8, v68, v9, v8
    v_dot2_f32_bf16 v8, v69, v9, v8
    v_dot2_f32_bf16 v8, v70, v9, v8
    v_dot2_f32_bf16 v8, v71, v9, v8
    buffer_store_dwordx4 v[68:71], v7, s[36:39], 0 offen offset:1024
    s_waitcnt vmcnt(24)
    v_lshl_or_b32 v72, v33, 16, v32
    v_lshl_or_b32 v73, v35, 16, v34
    v_lshl_or_b32 v74, v37, 16, v36
    v_lshl_or_b32 v75, v39, 16, v38
    v_dot2_f32_bf16 v8, v72, v9, v8
    v_dot2_f32_bf16 v8, v73, v9, v8
    v_dot2_f32_bf16 v8, v74, v9, v8
    v_dot2_f32_bf16 v8, v75, v9, v8
    buffer_store_dwordx4 v[72:75], v7, s[36:39], 0 offen offset:2048
    s_waitcnt vmcnt(16)
    v_lshl_or_b32 v76, v41, 16, v40
    v_lshl_or_b32 v77, v43, 16, v42
    v_lshl_or_b32 v78, v45, 16, v44
    v_lshl_or_b32 v79, v47, 16, v46
    v_dot2_f32_bf16 v8, v76, v9, v8
    v_dot2_f32_bf16 v8, v77, v9, v8
    v_dot2_f32_bf16 v8, v78, v9, v8
    v_dot2_f32_bf16 v8, v79, v9, v8
    buffer_store_dwordx4 v[76:79], v7, s[36:39], 0 offen offset:3072
    s_waitcnt vmcnt(8)
    v_lshl_or_b32 v80, v49, 16, v48
    v_lshl_or_b32 v81, v51, 16, v50
    v_lshl_or_b32 v82, v53, 16, v52
    v_lshl_or_b32 v83, v55, 16, v54
    v_dot2_f32_bf16 v8, v80, v9, v8
    v_dot2_f32_bf16 v8, v81, v9, v8
    v_dot2_f32_bf16 v8, v82, v9, v8
    v_dot2_f32_bf16 v8, v83, v9, v8
    v_add_u32 v7, 4096, v7
    buffer_store_dwordx4 v[80:83], v7, s[36:39], 0 offen offset:0
    s_waitcnt vmcnt(0)
    v_lshl_or_b32 v84, v57, 16, v56
    v_lshl_or_b32 v85, v59, 16, v58
    v_lshl_or_b32 v86, v61, 16, v60
    v_lshl_or_b32 v87, v63, 16, v62
    v_dot2_f32_bf16 v8, v84, v9, v8
    v_dot2_f32_bf16 v8, v85, v9, v8
    v_dot2_f32_bf16 v8, v86, v9, v8
    v_dot2_f32_bf16 v8, v87, v9, v8
    buffer_store_dwordx4 v[84:87], v7, s[36:39], 0 offen offset:1024
    s_cmp_eq_u32 s31, -1
    s_cbranch_scc1 prep_fin
    s_nop 2
    v_mov_b32 v10, v8
    s_nop 1
    v_permlane16_swap_b32 v8, v10
    v_add_f32 v8, v8, v10
    v_mov_b32 v10, v8
    s_nop 1
    v_permlane32_swap_b32 v8, v10
    v_add_f32 v8, v8, v10
    v_lshlrev_b32 v11, 2, v3
    s_mul_i32 s23, s35, 16384
    s_add_u32 s31, s31, s23
    v_add_u32 v11, s31, v11
    s_mov_b64 exec, 0xffff
    buffer_store_dword v8, v11, s[36:39], 0 offen
    s_mov_b64 exec, -1
    s_branch prep_fin
prep_stats:
    s_mov_b32 s24, s18
    s_mov_b32 s25, s19
    s_mov_b32 s26, 2359296
    s_mov_b32 s27, 0x00020000
    s_lshl_b32 s22, s35, 4
    v_lshrrev_b32 v5, 2, v2
    v_add_u32 v5, s22, v5
    v_and_b32 v6, 3, v2
    v_mul_u32_u24 v7, 1152, v5
    v_lshl_add_u32 v7, v6, 4, v7
    buffer_load_dwordx4 v[16:19], v7, s[24:27], 0 offen offset:0
    buffer_load_dwordx4 v[20:23], v7, s[24:27], 0 offen offset:64
    buffer_load_dwordx4 v[24:27], v7, s[24:27], 0 offen offset:128
    buffer_load_dwordx4 v[28:31], v7, s[24:27], 0 offen offset:192
    buffer_load_dwordx4 v[32:35], v7, s[24:27], 0 offen offset:256
    buffer_load_dwordx4 v[36:39], v7, s[24:27], 0 offen offset:320
    buffer_load_dwordx4 v[40:43], v7, s[24:27], 0 offen offset:384
    buffer_load_dwordx4 v[44:47], v7, s[24:27], 0 offen offset:448
    buffer_load_dwordx4 v[48:51], v7, s[24:27], 0 offen offset:512
    buffer_load_dwordx4 v[52:55], v7, s[24:27], 0 offen offset:576
    buffer_load_dwordx4 v[56:59], v7, s[24:27], 0 offen offset:640
    buffer_load_dwordx4 v[60:63], v7, s[24:27], 0 offen offset:704
    buffer_load_dwordx4 v[64:67], v7, s[24:27], 0 offen offset:768
    buffer_load_dwordx4 v[68:71], v7, s[24:27], 0 offen offset:832
    buffer_load_dwordx4 v[72:75], v7, s[24:27], 0 offen offset:896
    buffer_load_dwordx4 v[76:79], v7, s[24:27], 0 offen offset:960
    buffer_load_dwordx4 v[80:83], v7, s[24:27], 0 offen offset:1024
    buffer_load_dwordx4 v[84:87], v7, s[24:27], 0 offen offset:1088
    v_mov_b32 v8, 0
    v_mov_b32 v9, 0
    v_mov_b32 v10, 0x3f803f80
    s_waitcnt vmcnt(0)
    v_dot2_f32_bf16 v8, v16, v10, v8
    v_dot2_f32_bf16 v9, v16, v16, v9
    v_dot2_f32_bf16 v8, v17, v10, v8
    v_dot2_f32_bf16 v9, v17, v17, v9
    v_dot2_f32_bf16 v8, v18, v10, v8
    v_dot2_f32_bf16 v9, v18, v18, v9
    v_dot2_f32_bf16 v8, v19, v10, v8
    v_dot2_f32_bf16 v9, v19, v19, v9
    v_dot2_f32_bf16 v8, v20, v10, v8
    v_dot2_f32_bf16 v9, v20, v20, v9
    v_dot2_f32_bf16 v8, v21, v10, v8
    v_dot2_f32_bf16 v9, v21, v21, v9
    v_dot2_f32_bf16 v8, v22, v10, v8
    v_dot2_f32_bf16 v9, v22, v22, v9
    v_dot2_f32_bf16 v8, v23, v10, v8
    v_dot2_f32_bf16 v9, v23, v23, v9
    v_dot2_f32_bf16 v8, v24, v10, v8
    v_dot2_f32_bf16 v9, v24, v24, v9
    v_dot2_f32_bf16 v8, v25, v10, v8
    v_dot2_f32_bf16 v9, v25, v25, v9
    v_dot2_f32_bf16 v8, v26, v10, v8
    v_dot2_f32_bf16 v9, v26, v26, v9
    v_dot2_f32_bf16 v8, v27, v10, v8
    v_dot2_f32_bf16 v9, v27, v27, v9
    v_dot2_f32_bf16 v8, v28, v10, v8
    v_dot2_f32_bf16 v9, v28, v28, v9
    v_dot2_f32_bf16 v8, v29, v10, v8
    v_dot2_f32_bf16 v9, v29, v29, v9
    v_dot2_f32_bf16 v8, v30, v10, v8
    v_dot2_f32_bf16 v9, v30, v30, v9
    v_dot2_f32_bf16 v8, v31, v10, v8
    v_dot2_f32_bf16 v9, v31, v31, v9
    v_dot2_f32_bf16 v8, v32, v10, v8
    v_dot2_f32_bf16 v9, v32, v32, v9
    v_dot2_f32_bf16 v8, v33, v10, v8
    v_dot2_f32_bf16 v9, v33, v33, v9
    v_dot2_f32_bf16 v8, v34, v10, v8
    v_dot2_f32_bf16 v9, v34, v34, v9
    v_dot2_f32_bf16 v8, v35, v10, v8
    v_dot2_f32_bf16 v9, v35, v35, v9
    v_dot2_f32_bf16 v8, v36, v10, v8
    v_dot2_f32_bf16 v9, v36, v36, v9
    v_dot2_f32_bf16 v8, v37, v10, v8
    v_dot2_f32_bf16 v9, v37, v37, v9
    v_dot2_f32_bf16 v8, v38, v10, v8
    v_dot2_f32_bf16 v9, v38, v38, v9
    v_dot2_f32_bf16 v8, v39, v10, v8
    v_dot2_f32_bf16 v9, v39, v39, v9
    v_dot2_f32_bf16 v8, v40, v10, v8
    v_dot2_f32_bf16 v9, v40, v40, v9
    v_dot2_f32_bf16 v8, v41, v10, v8
    v_dot2_f32_bf16 v9, v41, v41, v9
    v_dot2_f32_bf16 v8, v42, v10, v8
    v_dot2_f32_bf16 v9, v42, v42, v9
    v_dot2_f32_bf16 v8, v43, v10, v8
    v_dot2_f32_bf16 v9, v43, v43, v9
    v_dot2_f32_bf16 v8, v44, v10, v8
    v_dot2_f32_bf16 v9, v44, v44, v9
    v_dot2_f32_bf16 v8, v45, v10, v8
    v_dot2_f32_bf16 v9, v45, v45, v9
    v_dot2_f32_bf16 v8, v46, v10, v8
    v_dot2_f32_bf16 v9, v46, v46, v9
    v_dot2_f32_bf16 v8, v47, v10, v8
    v_dot2_f32_bf16 v9, v47, v47, v9
    v_dot2_f32_bf16 v8, v48, v10, v8
    v_dot2_f32_bf16 v9, v48, v48, v9
    v_dot2_f32_bf16 v8, v49, v10, v8
    v_dot2_f32_bf16 v9, v49, v49, v9
    v_dot2_f32_bf16 v8, v50, v10, v8
    v_dot2_f32_bf16 v9, v50, v50, v9
    v_dot2_f32_bf16 v8, v51, v10, v8
    v_dot2_f32_bf16 v9, v51, v51, v9
    v_dot2_f32_bf16 v8, v52, v10, v8
    v_dot2_f32_bf16 v9, v52, v52, v9
    v_dot2_f32_bf16 v8, v53, v10, v8
    v_dot2_f32_bf16 v9, v53, v53, v9
    v_dot2_f32_bf16 v8, v54, v10, v8
    v_dot2_f32_bf16 v9, v54, v54, v9
    v_dot2_f32_bf16 v8, v55, v10, v8
    v_dot2_f32_bf16 v9, v55, v55, v9
    v_dot2_f32_bf16 v8, v56, v10, v8
    v_dot2_f32_bf16 v9, v56, v56, v9
    v_dot2_f32_bf16 v8, v57, v10, v8
    v_dot2_f32_bf16 v9, v57, v57, v9
    v_dot2_f32_bf16 v8, v58, v10, v8
    v_dot2_f32_bf16 v9, v58, v58, v9
    v_dot2_f32_bf16 v8, v59, v10, v8
    v_dot2_f32_bf16 v9, v59, v59, v9
    v_dot2_f32_bf16 v8, v60, v10, v8
    v_dot2_f32_bf16 v9, v60, v60, v9
    v_dot2_f32_bf16 v8, v61, v10, v8
    v_dot2_f32_bf16 v9, v61, v61, v9
    v_dot2_f32_bf16 v8, v62, v10, v8
    v_dot2_f32_bf16 v9, v62, v62, v9
    v_dot2_f32_bf16 v8, v63, v10, v8
    v_dot2_f32_bf16 v9, v63, v63, v9
    v_dot2_f32_bf16 v8, v64, v10, v8
    v_dot2_f32_bf16 v9, v64, v64, v9
    v_dot2_f32_bf16 v8, v65, v10, v8
    v_dot2_f32_bf16 v9, v65, v65, v9
    v_dot2_f32_bf16 v8, v66, v10, v8
    v_dot2_f32_bf16 v9, v66, v66, v9
    v_dot2_f32_bf16 v8, v67, v10, v8
    v_dot2_f32_bf16 v9, v67, v67, v9
    v_dot2_f32_bf16 v8, v68, v10, v8
    v_dot2_f32_bf16 v9, v68, v68, v9
    v_dot2_f32_bf16 v8, v69, v10, v8
    v_dot2_f32_bf16 v9, v69, v69, v9
    v_dot2_f32_bf16 v8, v70, v10, v8
    v_dot2_f32_bf16 v9, v70, v70, v9
    v_dot2_f32_bf16 v8, v71, v10, v8
    v_dot2_f32_bf16 v9, v71, v71, v9
    v_dot2_f32_bf16 v8, v72, v10, v8
    v_dot2_f32_bf16 v9, v72, v72, v9
    v_dot2_f32_bf16 v8, v73, v10, v8
    v_dot2_f32_bf16 v9, v73, v73, v9
    v_dot2_f32_bf16 v8, v74, v10, v8
    v_dot2_f32_bf16 v9, v74, v74, v9
    v_dot2_f32_bf16 v8, v75, v10, v8
    v_dot2_f32_bf16 v9, v75, v75, v9
    v_dot2_f32_bf16 v8, v76, v10, v8
    v_dot2_f32_bf16 v9, v76, v76, v9
    v_dot2_f32_bf16 v8, v77, v10, v8
    v_dot2_f32_bf16 v9, v77, v77, v9
    v_dot2_f32_bf16 v8, v78, v10, v8
    v_dot2_f32_bf16 v9, v78, v78, v9
    v_dot2_f32_bf16 v8, v79, v10, v8
    v_dot2_f32_bf16 v9, v79, v79, v9
    v_dot2_f32_bf16 v8, v80, v10, v8
    v_dot2_f32_bf16 v9, v80, v80, v9
    v_dot2_f32_bf16 v8, v81, v10, v8
    v_dot2_f32_bf16 v9, v81, v81, v9
    v_dot2_f32_bf16 v8, v82, v10, v8
    v_dot2_f32_bf16 v9, v82, v82, v9
    v_dot2_f32_bf16 v8, v83, v10, v8
    v_dot2_f32_bf16 v9, v83, v83, v9
    v_dot2_f32_bf16 v8, v84, v10, v8
    v_dot2_f32_bf16 v9, v84, v84, v9
    v_dot2_f32_bf16 v8, v85, v10, v8
    v_dot2_f32_bf16 v9, v85, v85, v9
    v_dot2_f32_bf16 v8, v86, v10, v8
    v_dot2_f32_bf16 v9, v86, v86, v9
    v_dot2_f32_bf16 v8, v87, v10, v8
    v_dot2_f32_bf16 v9, v87, v87, v9
    s_nop 3
    v_add_f32_dpp v8, v8, v8 quad_perm:[1,0,3,2] row_mask:0xf bank_mask:0xf
    v_add_f32_dpp v9, v9, v9 quad_perm:[1,0,3,2] row_mask:0xf bank_mask:0xf
    s_nop 1
    v_add_f32_dpp v8, v8, v8 quad_perm:[2,3,0,1] row_mask:0xf bank_mask:0xf
    v_add_f32_dpp v9, v9, v9 quad_perm:[2,3,0,1] row_mask:0xf bank_mask:0xf
    v_cmp_eq_u32 vcc, 0, v6
    v_lshlrev_b32 v11, 5, v5
    v_lshl_add_u32 v11, v6, 3, v11
    v_add_u32 v11, 4784128, v11
    v_cndmask_b32 v8, 0, v8, vcc
    v_cndmask_b32 v9, 0, v9, vcc
    buffer_store_dwordx2 v[8:9], v11, s[36:39], 0 offen
prep_fin:
prep_end:
    s_endpgm
.globl qkva0_kernel
.type qkva0_kernel,@function
.p2align 8
qkva0_kernel:
    s_cmp_ge_u32 s2, 256
    s_cbranch_scc1 qkva0_end
    s_load_dwordx2 s[4:5], s[0:1], 0
    s_load_dwordx2 s[6:7], s[0:1], 80
    s_and_b32 s12, s2, 63
    s_lshr_b32 s13, s2, 6
    v_lshrrev_b32 v1, 6, v0
    v_and_b32 v2, 63, v0
    v_and_b32 v3, 15, v2
    v_readfirstlane_b32 s14, v1
    v_lshrrev_b32 v4, 4, v2
    v_mul_u32_u24 v5, 1152, v3
    v_lshl_add_u32 v5, v4, 4, v5
    v_lshlrev_b32 v6, 4, v2
    s_mul_i32 s15, s12, 36864
    s_lshl_b32 s26, s12, 5
    s_waitcnt lgkmcnt(0)
    s_mov_b32 s16, s4
    s_mov_b32 s17, s5
    s_mov_b32 s18, 2359296
    s_mov_b32 s19, 0x00020000
    s_mov_b32 s20, s6
    s_mov_b32 s21, s7
    s_mov_b32 s22, 268435456
    s_mov_b32 s23, 0x00020000
    s_cmp_lg_u32 s14, 0
    s_cbranch_scc1 qkva0_nost
    v_and_b32 v11, 31, v2
    v_add_u32 v11, s26, v11
    v_lshlrev_b32 v11, 5, v11
    v_add_u32 v11, 4784128, v11
    buffer_load_dwordx4 v[128:131], v11, s[20:23], 0 offen
    buffer_load_dwordx4 v[132:135], v11, s[20:23], 0 offen offset:16
qkva0_nost:
    s_mov_b32 s40, s14
    s_mul_i32 s41, s40, 57
    s_lshr_b32 s41, s41, 10
    s_mul_i32 s42, s41, 18
    s_sub_u32 s42, s40, s42
    s_lshl_b32 s42, s42, 6
    s_mul_i32 s41, s41, 18432
    s_add_u32 s42, s42, s41
    s_add_u32 s42, s42, s15
    s_lshl_b32 s43, s40, 10
    s_mov_b32 m0, s43
    s_add_u32 s40, s40, 10
    buffer_load_dwordx4 v5, s[16:19], s42 offen lds
    s_mul_i32 s41, s40, 57
    s_lshr_b32 s41, s41, 10
    s_mul_i32 s42, s41, 18
    s_sub_u32 s42, s40, s42
    s_lshl_b32 s42, s42, 6
    s_mul_i32 s41, s41, 18432
    s_add_u32 s42, s42, s41
    s_add_u32 s42, s42, s15
    s_lshl_b32 s43, s40, 10
    s_mov_b32 m0, s43
    s_add_u32 s40, s40, 10
    buffer_load_dwordx4 v5, s[16:19], s42 offen lds
    s_mul_i32 s41, s40, 57
    s_lshr_b32 s41, s41, 10
    s_mul_i32 s42, s41, 18
    s_sub_u32 s42, s40, s42
    s_lshl_b32 s42, s42, 6
    s_mul_i32 s41, s41, 18432
    s_add_u32 s42, s42, s41
    s_add_u32 s42, s42, s15
    s_lshl_b32 s43, s40, 10
    s_mov_b32 m0, s43
    s_add_u32 s40, s40, 10
    buffer_load_dwordx4 v5, s[16:19], s42 offen lds
    s_cmp_ge_u32 s40, 36
    s_cbranch_scc1 qkva0_dmadone
    s_mul_i32 s41, s40, 57
    s_lshr_b32 s41, s41, 10
    s_mul_i32 s42, s41, 18
    s_sub_u32 s42, s40, s42
    s_lshl_b32 s42, s42, 6
    s_mul_i32 s41, s41, 18432
    s_add_u32 s42, s42, s41
    s_add_u32 s42, s42, s15
    s_lshl_b32 s43, s40, 10
    s_mov_b32 m0, s43
    s_add_u32 s40, s40, 10
    buffer_load_dwordx4 v5, s[16:19], s42 offen lds
qkva0_dmadone:
    s_barrier
    s_mul_i32 s24, s13, 10
    s_add_u32 s24, s24, s14
    s_mul_i32 s25, s24, 18432
    s_add_u32 s25, s25, 0
    buffer_load_dwordx4 v[56:59], v6, s[20:23], s25 offen offset:0
    buffer_load_dwordx4 v[60:63], v6, s[20:23], s25 offen offset:1024
    buffer_load_dwordx4 v[64:67], v6, s[20:23], s25 offen offset:2048
    buffer_load_dwordx4 v[68:71], v6, s[20:23], s25 offen offset:3072
    s_add_u32 s25, s25, 4096
    buffer_load_dwordx4 v[72:75], v6, s[20:23], s25 offen offset:0
    buffer_load_dwordx4 v[76:79], v6, s[20:23], s25 offen offset:1024
    buffer_load_dwordx4 v[80:83], v6, s[20:23], s25 offen offset:2048
    buffer_load_dwordx4 v[84:87], v6, s[20:23], s25 offen offset:3072
    s_add_u32 s25, s25, 4096
    buffer_load_dwordx4 v[88:91], v6, s[20:23], s25 offen offset:0
    v_add_u32 v7, s26, v3
    s_lshl_b32 s27, s24, 4
    v_lshl_add_u32 v10, v4, 2, s27
    v_mul_u32_u24 v8, 1152, v7
    v_lshl_add_u32 v8, v10, 1, v8
    v_add_u32 v9, 18432, v8
    v_lshlrev_b32 v12, 2, v10
    v_add_u32 v12, 4653056, v12
    buffer_load_dwordx4 v[144:147], v12, s[20:23], 0 offen
    s_mov_b32 s27, 16384
    s_mov_b32 s28, 32768
    buffer_load_dwordx4 v[148:151], v12, s[20:23], s27 offen
    buffer_load_dwordx4 v[136:139], v12, s[20:23], s28 offen
    s_waitcnt vmcnt(12)
    s_cmp_lg_u32 s14, 0
    s_cbranch_scc1 qkva0_nost2
    v_add_f32 v128, v128, v130
    v_add_f32 v129, v129, v131
    v_add_f32 v132, v132, v134
    v_add_f32 v133, v133, v135
    v_add_f32 v128, v128, v132
    v_add_f32 v129, v129, v133
    v_mul_f32 v128, 0x3ae38e39, v128
    v_mul_f32 v129, 0x3ae38e39, v129
    v_fma_f32 v129, -v128, v128, v129
    v_max_f32 v129, 0, v129
    v_cvt_pk_bf16_f32 v152, v128, v129
    v_and_b32 v130, 0xffff0000, v152
    v_lshlrev_b32 v129, 16, v152
    v_add_f32 v130, 0x3727c5ac, v130
    v_cvt_pk_bf16_f32 v152, v130, v130
    v_lshlrev_b32 v130, 16, v152
    v_sqrt_f32 v130, v130
    s_nop 0
    v_cvt_pk_bf16_f32 v152, v130, v130
    v_lshlrev_b32 v130, 16, v152
    v_rcp_f32 v128, v130
    s_nop 0
    v_lshlrev_b32 v11, 3, v2
    s_mov_b32 exec_lo, -1
    s_mov_b32 exec_hi, 0
    ds_write_b64 v11, v[128:129] offset:36864
    s_mov_b64 exec, -1
    s_waitcnt lgkmcnt(0)
qkva0_nost2:
    s_barrier
    v_mov_b32 v48, 0
    v_mov_b32 v49, 0
    v_mov_b32 v50, 0
    v_mov_b32 v51, 0
    v_mov_b32 v52, 0
    v_mov_b32 v53, 0
    v_mov_b32 v54, 0
    v_mov_b32 v55, 0
    v_lshlrev_b32 v11, 3, v3
    ds_read_b64 v[128:129], v11 offset:36864
    ds_read_b64 v[130:131], v11 offset:36992
    ds_read_b128 v[16:19], v6 offset:0
    ds_read_b128 v[20:23], v6 offset:18432
    ds_read_b128 v[24:27], v6 offset:1024
    ds_read_b128 v[28:31], v6 offset:19456
    ds_read_b128 v[32:35], v6 offset:2048
    ds_read_b128 v[36:39], v6 offset:20480
    ds_read_b128 v[40:43], v6 offset:3072
    ds_read_b128 v[44:47], v6 offset:21504
    buffer_load_dwordx4 v[92:95], v6, s[20:23], s25 offen offset:1024
    s_waitcnt vmcnt(12) lgkmcnt(6)
    v_mfma_f32_16x16x32_bf16 v[48:51], v[56:59], v[16:19], v[48:51]
    v_mfma_f32_16x16x32_bf16 v[52:55], v[56:59], v[20:23], v[52:55]
    ds_read_b128 v[16:19], v6 offset:4096
    ds_read_b128 v[20:23], v6 offset:22528
    buffer_load_dwordx4 v[96:99], v6, s[20:23], s25 offen offset:2048
    s_waitcnt vmcnt(12) lgkmcnt(6)
    v_mfma_f32_16x16x32_bf16 v[48:51], v[60:63], v[24:27], v[48:51]
    v_mfma_f32_16x16x32_bf16 v[52:55], v[60:63], v[28:31], v[52:55]
    ds_read_b128 v[24:27], v6 offset:5120
    ds_read_b128 v[28:31], v6 offset:23552
    buffer_load_dwordx4 v[100:103], v6, s[20:23], s25 offen offset:3072
    s_waitcnt vmcnt(12) lgkmcnt(6)
    v_mfma_f32_16x16x32_bf16 v[48:51], v[64:67], v[32:35], v[48:51]
    v_mfma_f32_16x16x32_bf16 v[52:55], v[64:67], v[36:39], v[52:55]
    ds_read_b128 v[32:35], v6 offset:6144
    ds_read_b128 v[36:39], v6 offset:24576
    s_add_u32 s25, s25, 4096
    buffer_load_dwordx4 v[104:107], v6, s[20:23], s25 offen offset:0
    s_waitcnt vmcnt(12) lgkmcnt(6)
    v_mfma_f32_16x16x32_bf16 v[48:51], v[68:71], v[40:43], v[48:51]
    v_mfma_f32_16x16x32_bf16 v[52:55], v[68:71], v[44:47], v[52:55]
    ds_read_b128 v[40:43], v6 offset:7168
    ds_read_b128 v[44:47], v6 offset:25600
    buffer_load_dwordx4 v[108:111], v6, s[20:23], s25 offen offset:1024
    s_waitcnt vmcnt(12) lgkmcnt(6)
    v_mfma_f32_16x16x32_bf16 v[48:51], v[72:75], v[16:19], v[48:51]
    v_mfma_f32_16x16x32_bf16 v[52:55], v[72:75], v[20:23], v[52:55]
    ds_read_b128 v[16:19], v6 offset:8192
    ds_read_b128 v[20:23], v6 offset:26624
    buffer_load_dwordx4 v[112:115], v6, s[20:23], s25 offen offset:2048
    s_waitcnt vmcnt(12) lgkmcnt(6)
    v_mfma_f32_16x16x32_bf16 v[48:51], v[76:79], v[24:27], v[48:51]
    v_mfma_f32_16x16x32_bf16 v[52:55], v[76:79], v[28:31], v[52:55]
    ds_read_b128 v[24:27], v6 offset:9216
    ds_read_b128 v[28:31], v6 offset:27648
    buffer_load_dwordx4 v[116:119], v6, s[20:23], s25 offen offset:3072
    s_waitcnt vmcnt(12) lgkmcnt(6)
    v_mfma_f32_16x16x32_bf16 v[48:51], v[80:83], v[32:35], v[48:51]
    v_mfma_f32_16x16x32_bf16 v[52:55], v[80:83], v[36:39], v[52:55]
    ds_read_b128 v[32:35], v6 offset:10240
    ds_read_b128 v[36:39], v6 offset:28672
    s_add_u32 s25, s25, 4096
    buffer_load_dwordx4 v[120:123], v6, s[20:23], s25 offen offset:0
    s_waitcnt vmcnt(12) lgkmcnt(6)
    v_mfma_f32_16x16x32_bf16 v[48:51], v[84:87], v[40:43], v[48:51]
    v_mfma_f32_16x16x32_bf16 v[52:55], v[84:87], v[44:47], v[52:55]
    ds_read_b128 v[40:43], v6 offset:11264
    ds_read_b128 v[44:47], v6 offset:29696
    buffer_load_dwordx4 v[124:127], v6, s[20:23], s25 offen offset:1024
    s_waitcnt vmcnt(12) lgkmcnt(6)
    v_mfma_f32_16x16x32_bf16 v[48:51], v[88:91], v[16:19], v[48:51]
    v_mfma_f32_16x16x32_bf16 v[52:55], v[88:91], v[20:23], v[52:55]
    ds_read_b128 v[16:19], v6 offset:12288
    ds_read_b128 v[20:23], v6 offset:30720
    s_waitcnt vmcnt(8) lgkmcnt(6)
    v_mfma_f32_16x16x32_bf16 v[48:51], v[92:95], v[24:27], v[48:51]
    v_mfma_f32_16x16x32_bf16 v[52:55], v[92:95], v[28:31], v[52:55]
    ds_read_b128 v[24:27], v6 offset:13312
    ds_read_b128 v[28:31], v6 offset:31744
    s_waitcnt vmcnt(7) lgkmcnt(6)
    v_mfma_f32_16x16x32_bf16 v[48:51], v[96:99], v[32:35], v[48:51]
    v_mfma_f32_16x16x32_bf16 v[52:55], v[96:99], v[36:39], v[52:55]
    ds_read_b128 v[32:35], v6 offset:14336
    ds_read_b128 v[36:39], v6 offset:32768
    s_waitcnt vmcnt(6) lgkmcnt(6)
    v_mfma_f32_16x16x32_bf16 v[48:51], v[100:103], v[40:43], v[48:51]
    v_mfma_f32_16x16x32_bf16 v[52:55], v[100:103], v[44:47], v[52:55]
    ds_read_b128 v[40:43], v6 offset:15360
    ds_read_b128 v[44:47], v6 offset:33792
    s_waitcnt vmcnt(5) lgkmcnt(6)
    v_mfma_f32_16x16x32_bf16 v[48:51], v[104:107], v[16:19], v[48:51]
    v_mfma_f32_16x16x32_bf16 v[52:55], v[104:107], v[20:23], v[52:55]
    ds_read_b128 v[16:19], v6 offset:16384
    ds_read_b128 v[20:23], v6 offset:34816
    s_waitcnt vmcnt(4) lgkmcnt(6)
    v_mfma_f32_16x16x32_bf16 v[48:51], v[108:111], v[24:27], v[48:51]
    v_mfma_f32_16x16x32_bf16 v[52:55], v[108:111], v[28:31], v[52:55]
    ds_read_b128 v[24:27], v6 offset:17408
    ds_read_b128 v[28:31], v6 offset:35840
    s_waitcnt vmcnt(3) lgkmcnt(6)
    v_mfma_f32_16x16x32_bf16 v[48:51], v[112:115], v[32:35], v[48:51]
    v_mfma_f32_16x16x32_bf16 v[52:55], v[112:115], v[36:39], v[52:55]
    s_waitcnt vmcnt(2) lgkmcnt(4)
    v_mfma_f32_16x16x32_bf16 v[48:51], v[116:119], v[40:43], v[48:51]
    v_mfma_f32_16x16x32_bf16 v[52:55], v[116:119], v[44:47], v[52:55]
    s_waitcnt vmcnt(1) lgkmcnt(2)
    v_mfma_f32_16x16x32_bf16 v[48:51], v[120:123], v[16:19], v[48:51]
    v_mfma_f32_16x16x32_bf16 v[52:55], v[120:123], v[20:23], v[52:55]
    s_waitcnt vmcnt(0) lgkmcnt(0)
    v_mfma_f32_16x16x32_bf16 v[48:51], v[124:127], v[24:27], v[48:51]
    v_mfma_f32_16x16x32_bf16 v[52:55], v[124:127], v[28:31], v[52:55]
    s_waitcnt vmcnt(0)
    s_nop 7
    v_add_f32 v144, v144, v148
    v_add_f32 v144, v144, v136
    v_add_f32 v145, v145, v149
    v_add_f32 v145, v145, v137
    v_add_f32 v146, v146, v150
    v_add_f32 v146, v146, v138
    v_add_f32 v147, v147, v151
    v_add_f32 v147, v147, v139
    v_fma_f32 v48, -v129, v144, v48
    v_fma_f32 v49, -v129, v145, v49
    v_fma_f32 v50, -v129, v146, v50
    v_fma_f32 v51, -v129, v147, v51
    v_fma_f32 v52, -v131, v144, v52
    v_fma_f32 v53, -v131, v145, v53
    v_fma_f32 v54, -v131, v146, v54
    v_fma_f32 v55, -v131, v147, v55
    s_cmp_ge_u32 s24, 36
    s_cbranch_scc1 qkva0_kv
    v_mul_f32 v152, 0x3eae1a93, v128
    v_mul_f32 v48, v152, v48
    v_mul_f32 v49, v152, v49
    v_mul_f32 v50, v152, v50
    v_mul_f32 v51, v152, v51
    v_cvt_pk_bf16_f32 v148, v48, v49
    v_cvt_pk_bf16_f32 v149, v50, v51
    v_add_u32 v153, 5242880, v8
    buffer_store_dwordx2 v[148:149], v153, s[20:23], 0 offen
    v_mul_f32 v152, 0x3eae1a93, v130
    v_mul_f32 v52, v152, v52
    v_mul_f32 v53, v152, v53
    v_mul_f32 v54, v152, v54
    v_mul_f32 v55, v152, v55
    v_cvt_pk_bf16_f32 v150, v52, v53
    v_cvt_pk_bf16_f32 v151, v54, v55
    v_add_u32 v153, 5242880, v9
    buffer_store_dwordx2 v[150:151], v153, s[20:23], 0 offen
    s_branch qkva0_fin
qkva0_kv:
    v_mul_f32 v48, v128, v48
    v_mul_f32 v49, v128, v49
    v_mul_f32 v50, v128, v50
    v_mul_f32 v51, v128, v51
    v_mul_f32 v52, v130, v52
    v_mul_f32 v53, v130, v53
    v_mul_f32 v54, v130, v54
    v_mul_f32 v55, v130, v55
    s_cmp_ge_u32 s24, 38
    s_cbranch_scc1 qkva0_vpart
    v_mov_b32 v158, 0
    v_mul_f32 v157, v48, v48
    v_fmac_f32 v157, v49, v49
    v_fmac_f32 v157, v50, v50
    v_fmac_f32 v157, v51, v51
    v_mov_b32 v156, v157
    s_nop 1
    v_permlane16_swap_b32 v157, v156
    v_add_f32 v157, v157, v156
    v_mov_b32 v156, v157
    s_nop 1
    v_permlane32_swap_b32 v157, v156
    v_add_f32 v157, v157, v156
    v_max_f32 v158, v158, v157
    v_mul_f32 v157, v52, v52
    v_fmac_f32 v157, v53, v53
    v_fmac_f32 v157, v54, v54
    v_fmac_f32 v157, v55, v55
    v_mov_b32 v156, v157
    s_nop 1
    v_permlane16_swap_b32 v157, v156
    v_add_f32 v157, v157, v156
    v_mov_b32 v156, v157
    s_nop 1
    v_permlane32_swap_b32 v157, v156
    v_add_f32 v157, v157, v156
    v_max_f32 v158, v158, v157
    s_nop 1
    v_max_f32_dpp v158, v158, v158 quad_perm:[1,0,3,2] row_mask:0xf bank_mask:0xf
    s_nop 1
    v_max_f32_dpp v158, v158, v158 quad_perm:[2,3,0,1] row_mask:0xf bank_mask:0xf
    s_nop 1
    v_max_f32_dpp v158, v158, v158 row_half_mirror row_mask:0xf bank_mask:0xf
    s_nop 1
    v_max_f32_dpp v158, v158, v158 row_mirror row_mask:0xf bank_mask:0xf
    s_sub_u32 s27, s24, 36
    s_lshl_b32 s27, s27, 8
    s_lshl_b32 s28, s12, 2
    s_add_u32 s27, s27, s28
    s_add_u32 s27, s27, 4734976
    v_mov_b32 v157, 0
    s_mov_b64 exec, 1
    buffer_store_dword v158, v157, s[20:23], s27 offen
    s_mov_b64 exec, -1
    s_mul_i32 s28, s12, 2496
    s_add_u32 s28, s28, 7864320
    s_cmp_eq_u32 s24, 37
    s_cbranch_scc1 qkva0_k1
    v_lshlrev_b32 v152, 4, v3
    v_lshrrev_b32 v153, 1, v4
    v_lshl_add_u32 v152, v153, 9, v152
    v_and_b32 v153, 1, v4
    v_lshl_add_u32 v152, v153, 3, v152
    v_cvt_pk_bf16_f32 v148, v48, v49
    v_cvt_pk_bf16_f32 v149, v50, v51
    buffer_store_dwordx2 v[148:149], v152, s[20:23], s28 offen offset:0
    v_cvt_pk_bf16_f32 v150, v52, v53
    v_cvt_pk_bf16_f32 v151, v54, v55
    buffer_store_dwordx2 v[150:151], v152, s[20:23], s28 offen offset:256
    s_branch qkva0_fin
qkva0_k1:
    v_lshlrev_b32 v152, 3, v3
    s_mov_b64 exec, 0xffff
    v_cvt_pk_bf16_f32 v148, v48, v49
    v_mov_b32 v149, 0x3f80
    buffer_store_dwordx2 v[148:149], v152, s[20:23], s28 offen offset:1024
    v_cvt_pk_bf16_f32 v150, v52, v53
    v_mov_b32 v151, 0x3f80
    buffer_store_dwordx2 v[150:151], v152, s[20:23], s28 offen offset:1152
    s_mov_b64 exec, -1
    s_branch qkva0_fin
qkva0_vpart:
    s_mul_i32 s28, s12, 2496
    s_add_u32 s28, s28, 7865600
    v_bfe_u32 v153, v3, 2, 1
    v_mul_u32_u24 v152, 304, v153
    v_and_b32 v153, 3, v3
    v_lshl_add_u32 v152, v153, 1, v152
    v_lshrrev_b32 v153, 3, v3
    v_lshl_add_u32 v152, v153, 3, v152
    s_cmp_eq_u32 s24, 39
    s_cbranch_scc1 qkva0_v1
    v_lshl_add_u32 v152, v4, 6, v152
    v_cvt_pk_bf16_f32 v132, v48, v48
    buffer_store_short v132, v152, s[20:23], s28 offen offset:0
    v_cvt_pk_bf16_f32 v133, v49, v49
    buffer_store_short v133, v152, s[20:23], s28 offen offset:16
    v_cvt_pk_bf16_f32 v134, v50, v50
    buffer_store_short v134, v152, s[20:23], s28 offen offset:32
    v_cvt_pk_bf16_f32 v135, v51, v51
    buffer_store_short v135, v152, s[20:23], s28 offen offset:48
    v_cvt_pk_bf16_f32 v132, v52, v52
    buffer_store_short v132, v152, s[20:23], s28 offen offset:608
    v_cvt_pk_bf16_f32 v133, v53, v53
    buffer_store_short v133, v152, s[20:23], s28 offen offset:624
    v_cvt_pk_bf16_f32 v134, v54, v54
    buffer_store_short v134, v152, s[20:23], s28 offen offset:640
    v_cvt_pk_bf16_f32 v135, v55, v55
    buffer_store_short v135, v152, s[20:23], s28 offen offset:656
    s_branch qkva0_fin
qkva0_v1:
    v_mov_b32 v134, 0x3f80
    s_mov_b64 exec, 0xffff
    v_cvt_pk_bf16_f32 v132, v48, v48
    v_cvt_pk_bf16_f32 v133, v49, v49
    buffer_store_short v132, v152, s[20:23], s28 offen offset:256
    buffer_store_short v133, v152, s[20:23], s28 offen offset:272
    buffer_store_short v134, v152, s[20:23], s28 offen offset:288
    v_cvt_pk_bf16_f32 v132, v52, v52
    v_cvt_pk_bf16_f32 v133, v53, v53
    buffer_store_short v132, v152, s[20:23], s28 offen offset:864
    buffer_store_short v133, v152, s[20:23], s28 offen offset:880
    buffer_store_short v134, v152, s[20:23], s28 offen offset:896
    s_mov_b64 exec, -1
qkva0_fin:
qkva0_end:
    s_endpgm
.globl attn_kernel
.type attn_kernel,@function
.p2align 8
attn_kernel:
    s_cmp_ge_u32 s2, 256
    s_cbranch_scc1 attn_end
    s_load_dwordx2 s[4:5], s[0:1], 80
    v_lshrrev_b32 v1, 6, v0
    v_and_b32 v2, 63, v0
    s_nop 0
    v_readfirstlane_b32 s14, v1
    v_and_b32 v3, 31, v2
    v_lshrrev_b32 v4, 5, v2
    s_waitcnt lgkmcnt(0)
    s_mov_b32 s16, s4
    s_mov_b32 s17, s5
    s_mov_b32 s18, 268435456
    s_mov_b32 s19, 0x00020000
    s_lshl_b32 s15, s2, 3
    s_add_u32 s15, s15, s14
    s_mul_i32 s20, s15, 1152
    s_add_u32 s21, s20, 5242880
    v_mul_u32_u24 v5, 36, v3
    v_lshl_add_u32 v6, v4, 4, v5
    buffer_load_dwordx4 v[8:11], v6, s[16:19], s21 offen
    buffer_load_dword v12, v5, s[16:19], s21 offen offset:32
    v_lshlrev_b32 v7, 2, v2
    s_mov_b32 s22, 4734976
    buffer_load_dword v118, v7, s[16:19], s22 offen
    buffer_load_dword v119, v7, s[16:19], s22 offen offset:256
    v_lshlrev_b32 v7, 4, v2
    s_lshl_b32 s22, s14, 10
    s_add_u32 s23, s22, 7864320
    s_mov_b32 m0, s22
    s_add_u32 s22, s22, 8192
    buffer_load_dwordx4 v7, s[16:19], s23 offen lds
    s_add_u32 s23, s23, 8192
    s_mov_b32 m0, s22
    s_add_u32 s22, s22, 8192
    buffer_load_dwordx4 v7, s[16:19], s23 offen lds
    s_add_u32 s23, s23, 8192
    s_mov_b32 m0, s22
    s_add_u32 s22, s22, 8192
    buffer_load_dwordx4 v7, s[16:19], s23 offen lds
    s_add_u32 s23, s23, 8192
    s_mov_b32 m0, s22
    s_add_u32 s22, s22, 8192
    buffer_load_dwordx4 v7, s[16:19], s23 offen lds
    s_add_u32 s23, s23, 8192
    v_lshlrev_b32 v113, 4, v3
    v_lshl_add_u32 v113, v4, 9, v113
    v_lshlrev_b32 v114, 3, v3
    v_add_u32 v114, 1024, v114
    v_min_u32 v115, 18, v3
    v_lshlrev_b32 v115, 4, v115
    v_mul_u32_u24 v116, 304, v4
    v_add_u32 v115, v115, v116
    v_add_u32 v115, 1280, v115
    v_mov_b32 v13, 0
    v_mov_b32 v14, 0
    v_mov_b32 v15, 0
    v_mov_b32 v22, 0
    v_mov_b32 v23, 0
    v_mov_b32 v30, 0
    v_mov_b32 v31, 0
    v_cmp_eq_u32 s[30:31], 0, v4
    s_nop 1
    s_waitcnt vmcnt(4)
    v_cndmask_b32 v12, 0, v12, s[30:31]
    v_dot2_f32_bf16 v116, v8, v8, 0
    v_dot2_f32_bf16 v116, v9, v9, v116
    v_dot2_f32_bf16 v116, v10, v10, v116
    v_dot2_f32_bf16 v116, v11, v11, v116
    v_dot2_f32_bf16 v116, v12, v12, v116
    v_mov_b32 v117, v118
    s_nop 1
    v_permlane16_swap_b32 v118, v117
    v_max_f32 v118, v118, v117
    v_mov_b32 v117, v118
    s_nop 1
    v_permlane32_swap_b32 v118, v117
    v_max_f32 v118, v118, v117
    s_nop 1
    v_max_f32_dpp v118, v118, v118 quad_perm:[1,0,3,2] row_mask:0xf bank_mask:0xf
    s_nop 1
    v_max_f32_dpp v118, v118, v118 quad_perm:[2,3,0,1] row_mask:0xf bank_mask:0xf
    s_nop 1
    v_max_f32_dpp v118, v118, v118 row_half_mirror row_mask:0xf bank_mask:0xf
    s_nop 1
    v_max_f32_dpp v118, v118, v118 row_mirror row_mask:0xf bank_mask:0xf
    v_mov_b32 v117, v119
    s_nop 1
    v_permlane16_swap_b32 v119, v117
    v_max_f32 v119, v119, v117
    v_mov_b32 v117, v119
    s_nop 1
    v_permlane32_swap_b32 v119, v117
    v_max_f32 v119, v119, v117
    s_nop 1
    v_max_f32_dpp v119, v119, v119 quad_perm:[1,0,3,2] row_mask:0xf bank_mask:0xf
    s_nop 1
    v_max_f32_dpp v119, v119, v119 quad_perm:[2,3,0,1] row_mask:0xf bank_mask:0xf
    s_nop 1
    v_max_f32_dpp v119, v119, v119 row_half_mirror row_mask:0xf bank_mask:0xf
    s_nop 1
    v_max_f32_dpp v119, v119, v119 row_mirror row_mask:0xf bank_mask:0xf
    v_add_f32 v118, v118, v119
    v_mov_b32 v117, v116
    s_nop 1
    v_permlane32_swap_b32 v116, v117
    v_add_f32 v116, v116, v117
    v_mul_f32 v116, v116, v118
    v_sqrt_f32 v116, v116
    s_nop 0
    v_mul_f32 v112, 0x3f828f5c, v116
    v_add_f32 v112, 0x3c23d70a, v112
    v_cmp_nge_f32 vcc, 0x42700000, v112
    s_cmp_lg_u64 vcc, 0
    s_cselect_b32 s25, 1, 0
    v_mov_b32 v116, s25
    v_mov_b32 v117, 159744
    v_lshl_add_u32 v117, v1, 2, v117
    ds_write_b32 v117, v116
    s_waitcnt vmcnt(2) lgkmcnt(0)
    s_barrier
    v_mov_b32 v117, 159744
    ds_read_b128 v[48:51], v117
    ds_read_b128 v[52:55], v117 offset:16
    s_waitcnt lgkmcnt(0)
    v_or3_b32 v116, v48, v49, v50
    v_or3_b32 v116, v116, v51, v52
    v_or3_b32 v116, v116, v53, v54
    v_or_b32 v116, v116, v55
    s_nop 0
    v_readfirstlane_b32 s26, v116
    s_nop 3
    s_cmp_eq_u32 s26, 0
    s_cbranch_scc1 attn_fast
    s_mov_b32 m0, s22
    s_add_u32 s22, s22, 8192
    buffer_load_dwordx4 v7, s[16:19], s23 offen lds
    s_add_u32 s23, s23, 8192
    s_mov_b32 m0, s22
    s_add_u32 s22, s22, 8192
    buffer_load_dwordx4 v7, s[16:19], s23 offen lds
    s_add_u32 s23, s23, 8192
    s_mov_b32 m0, s22
    s_add_u32 s22, s22, 8192
    buffer_load_dwordx4 v7, s[16:19], s23 offen lds
    s_add_u32 s23, s23, 8192
    s_mov_b32 m0, s22
    s_add_u32 s22, s22, 8192
    buffer_load_dwordx4 v7, s[16:19], s23 offen lds
    s_add_u32 s23, s23, 8192
    s_mov_b32 m0, s22
    s_add_u32 s22, s22, 8192
    buffer_load_dwordx4 v7, s[16:19], s23 offen lds
    s_add_u32 s23, s23, 8192
    s_mov_b32 m0, s22
    s_add_u32 s22, s22, 8192
    buffer_load_dwordx4 v7, s[16:19], s23 offen lds
    s_add_u32 s23, s23, 8192
    s_mov_b32 m0, s22
    s_add_u32 s22, s22, 8192
    buffer_load_dwordx4 v7, s[16:19], s23 offen lds
    s_add_u32 s23, s23, 8192
    s_mov_b32 m0, s22
    s_add_u32 s22, s22, 8192
    buffer_load_dwordx4 v7, s[16:19], s23 offen lds
    s_add_u32 s23, s23, 8192
    s_mov_b32 m0, s22
    s_add_u32 s22, s22, 8192
    buffer_load_dwordx4 v7, s[16:19], s23 offen lds
    s_add_u32 s23, s23, 8192
    s_mov_b32 m0, s22
    s_add_u32 s22, s22, 8192
    buffer_load_dwordx4 v7, s[16:19], s23 offen lds
    s_add_u32 s23, s23, 8192
    s_mov_b32 m0, s22
    s_add_u32 s22, s22, 8192
    buffer_load_dwordx4 v7, s[16:19], s23 offen lds
    s_add_u32 s23, s23, 8192
    s_mov_b32 m0, s22
    s_add_u32 s22, s22, 8192
    buffer_load_dwordx4 v7, s[16:19], s23 offen lds
    s_add_u32 s23, s23, 8192
    s_mov_b32 m0, s22
    s_add_u32 s22, s22, 8192
    buffer_load_dwordx4 v7, s[16:19], s23 offen lds
    s_add_u32 s23, s23, 8192
    s_mov_b32 m0, s22
    s_add_u32 s22, s22, 8192
    buffer_load_dwordx4 v7, s[16:19], s23 offen lds
    s_add_u32 s23, s23, 8192
    s_mov_b32 m0, s22
    s_add_u32 s22, s22, 8192
    buffer_load_dwordx4 v7, s[16:19], s23 offen lds
    s_add_u32 s23, s23, 8192
    s_cmp_ge_u32 s14, 4
    s_cbranch_scc1 attn_dmadones
    s_mov_b32 m0, s22
    s_add_u32 s22, s22, 8192
    buffer_load_dwordx4 v7, s[16:19], s23 offen lds
    s_add_u32 s23, s23, 8192
attn_dmadones:
    s_waitcnt vmcnt(0)
    s_barrier
    v_mov_b32 v112, 0xff7fffff
    s_mov_b32 s24, 8
attn_p1:
    ds_read_b128 v[16:19], v113 offset:0
    ds_read_b64 v[20:21], v114 offset:0
    ds_read_b128 v[24:27], v113 offset:2496
    ds_read_b64 v[28:29], v114 offset:2496
    s_waitcnt lgkmcnt(2)
    v_mfma_f32_32x32x16_bf16 v[48:63], v[16:19], v[8:11], 0
    v_mfma_f32_32x32x16_bf16 v[48:63], v[20:23], v[12:15], v[48:63]
    ds_read_b128 v[16:19], v113 offset:4992
    ds_read_b64 v[20:21], v114 offset:4992
    s_waitcnt lgkmcnt(2)
    v_mfma_f32_32x32x16_bf16 v[64:79], v[24:27], v[8:11], 0
    v_mfma_f32_32x32x16_bf16 v[64:79], v[28:31], v[12:15], v[64:79]
    s_nop 7
    v_max3_f32 v112, v112, v48, v49
    v_max3_f32 v112, v112, v50, v51
    v_max3_f32 v112, v112, v52, v53
    v_max3_f32 v112, v112, v54, v55
    v_max3_f32 v112, v112, v56, v57
    v_max3_f32 v112, v112, v58, v59
    v_max3_f32 v112, v112, v60, v61
    v_max3_f32 v112, v112, v62, v63
    ds_read_b128 v[24:27], v113 offset:7488
    ds_read_b64 v[28:29], v114 offset:7488
    s_waitcnt lgkmcnt(2)
    v_mfma_f32_32x32x16_bf16 v[48:63], v[16:19], v[8:11], 0
    v_mfma_f32_32x32x16_bf16 v[48:63], v[20:23], v[12:15], v[48:63]
    v_max3_f32 v112, v112, v64, v65
    v_max3_f32 v112, v112, v66, v67
    v_max3_f32 v112, v112, v68, v69
    v_max3_f32 v112, v112, v70, v71
    v_max3_f32 v112, v112, v72, v73
    v_max3_f32 v112, v112, v74, v75
    v_max3_f32 v112, v112, v76, v77
    v_max3_f32 v112, v112, v78, v79
    ds_read_b128 v[16:19], v113 offset:9984
    ds_read_b64 v[20:21], v114 offset:9984
    s_waitcnt lgkmcnt(2)
    v_mfma_f32_32x32x16_bf16 v[64:79], v[24:27], v[8:11], 0
    v_mfma_f32_32x32x16_bf16 v[64:79], v[28:31], v[12:15], v[64:79]
    v_max3_f32 v112, v112, v48, v49
    v_max3_f32 v112, v112, v50, v51
    v_max3_f32 v112, v112, v52, v53
    v_max3_f32 v112, v112, v54, v55
    v_max3_f32 v112, v112, v56, v57
    v_max3_f32 v112, v112, v58, v59
    v_max3_f32 v112, v112, v60, v61
    v_max3_f32 v112, v112, v62, v63
    ds_read_b128 v[24:27], v113 offset:12480
    ds_read_b64 v[28:29], v114 offset:12480
    s_waitcnt lgkmcnt(2)
    v_mfma_f32_32x32x16_bf16 v[48:63], v[16:19], v[8:11], 0
    v_mfma_f32_32x32x16_bf16 v[48:63], v[20:23], v[12:15], v[48:63]
    v_max3_f32 v112, v112, v64, v65
    v_max3_f32 v112, v112, v66, v67
    v_max3_f32 v112, v112, v68, v69
    v_max3_f32 v112, v112, v70, v71
    v_max3_f32 v112, v112, v72, v73
    v_max3_f32 v112, v112, v74, v75
    v_max3_f32 v112, v112, v76, v77
    v_max3_f32 v112, v112, v78, v79
    ds_read_b128 v[16:19], v113 offset:14976
    ds_read_b64 v[20:21], v114 offset:14976
    s_waitcnt lgkmcnt(2)
    v_mfma_f32_32x32x16_bf16 v[64:79], v[24:27], v[8:11], 0
    v_mfma_f32_32x32x16_bf16 v[64:79], v[28:31], v[12:15], v[64:79]
    v_max3_f32 v112, v112, v48, v49
    v_max3_f32 v112, v112, v50, v51
    v_max3_f32 v112, v112, v52, v53
    v_max3_f32 v112, v112, v54, v55
    v_max3_f32 v112, v112, v56, v57
    v_max3_f32 v112, v112, v58, v59
    v_max3_f32 v112, v112, v60, v61
    v_max3_f32 v112, v112, v62, v63
    ds_read_b128 v[24:27], v113 offset:17472
    ds_read_b64 v[28:29], v114 offset:17472
    s_waitcnt lgkmcnt(2)
    v_mfma_f32_32x32x16_bf16 v[48:63], v[16:19], v[8:11], 0
    v_mfma_f32_32x32x16_bf16 v[48:63], v[20:23], v[12:15], v[48:63]
    v_max3_f32 v112, v112, v64, v65
    v_max3_f32 v112, v112, v66, v67
    v_max3_f32 v112, v112, v68, v69
    v_max3_f32 v112, v112, v70, v71
    v_max3_f32 v112, v112, v72, v73
    v_max3_f32 v112, v112, v74, v75
    v_max3_f32 v112, v112, v76, v77
    v_max3_f32 v112, v112, v78, v79
    s_waitcnt lgkmcnt(0)
    v_mfma_f32_32x32x16_bf16 v[64:79], v[24:27], v[8:11], 0
    v_mfma_f32_32x32x16_bf16 v[64:79], v[28:31], v[12:15], v[64:79]
    v_max3_f32 v112, v112, v48, v49
    v_max3_f32 v112, v112, v50, v51
    v_max3_f32 v112, v112, v52, v53
    v_max3_f32 v112, v112, v54, v55
    v_max3_f32 v112, v112, v56, v57
    v_max3_f32 v112, v112, v58, v59
    v_max3_f32 v112, v112, v60, v61
    v_max3_f32 v112, v112, v62, v63
    s_nop 7
    s_nop 3
    v_max3_f32 v112, v112, v64, v65
    v_max3_f32 v112, v112, v66, v67
    v_max3_f32 v112, v112, v68, v69
    v_max3_f32 v112, v112, v70, v71
    v_max3_f32 v112, v112, v72, v73
    v_max3_f32 v112, v112, v74, v75
    v_max3_f32 v112, v112, v76, v77
    v_max3_f32 v112, v112, v78, v79
    v_add_u32 v113, 19968, v113
    v_add_u32 v114, 19968, v114
    s_sub_u32 s24, s24, 1
    s_cmp_lg_u32 s24, 0
    s_cbranch_scc1 attn_p1
    v_mov_b32 v117, v112
    s_nop 1
    v_permlane32_swap_b32 v112, v117
    v_max_f32 v112, v112, v117
    v_subrev_u32 v113, 159744, v113
    v_subrev_u32 v114, 159744, v114
attn_fast:
    v_sub_f32 v112, 0, v112
    v_cvt_pk_bf16_f32 v117, v112, 0
    v_and_b32 v117, 0xffff, v117
    v_cndmask_b32 v13, 0, v117, s[30:31]
    v_mov_b32 v96, 0
    v_mov_b32 v97, 0
    v_mov_b32 v98, 0
    v_mov_b32 v99, 0
    v_mov_b32 v100, 0
    v_mov_b32 v101, 0
    v_mov_b32 v102, 0
    v_mov_b32 v103, 0
    v_mov_b32 v104, 0
    v_mov_b32 v105, 0
    v_mov_b32 v106, 0
    v_mov_b32 v107, 0
    v_mov_b32 v108, 0
    v_mov_b32 v109, 0
    v_mov_b32 v110, 0
    v_mov_b32 v111, 0
    v_mov_b32 v88, 0
    v_mov_b32 v40, 0
    v_mov_b32 v89, 0
    v_mov_b32 v41, 0
    v_mov_b32 v90, 0
    v_mov_b32 v42, 0
    v_mov_b32 v91, 0
    v_mov_b32 v43, 0
    v_mov_b32 v92, 0
    v_mov_b32 v44, 0
    v_mov_b32 v93, 0
    v_mov_b32 v45, 0
    v_mov_b32 v94, 0
    v_mov_b32 v46, 0
    v_mov_b32 v95, 0
    v_mov_b32 v47, 0
    ds_read_b128 v[16:19], v113 offset:0
    ds_read_b64 v[20:21], v114 offset:0
    s_waitcnt lgkmcnt(0)
    v_mfma_f32_32x32x16_bf16 v[48:63], v[16:19], v[8:11], 0
    v_mfma_f32_32x32x16_bf16 v[48:63], v[20:23], v[12:15], v[48:63]
    ds_read_b128 v[24:27], v113 offset:2496
    ds_read_b64 v[28:29], v114 offset:2496
    s_mov_b32 s24, 0
    s_nop 7
attn_main:
    s_cmp_lg_u32 s26, 0
    s_cbranch_scc1 attn_nosync
    s_cmp_lg_u32 s24, 1
    s_cbranch_scc1 attn_nosync
    s_waitcnt vmcnt(0)
    s_barrier
attn_nosync:
    s_or_b32 s27, s26, s24
    s_cmp_lg_u32 s27, 0
    s_cbranch_scc1 attn_ns0
    s_mov_b32 m0, s22
    s_add_u32 s22, s22, 8192
    buffer_load_dwordx4 v7, s[16:19], s23 offen lds
    s_add_u32 s23, s23, 8192
    s_mov_b32 m0, s22
    s_add_u32 s22, s22, 8192
    buffer_load_dwordx4 v7, s[16:19], s23 offen lds
    s_add_u32 s23, s23, 8192
attn_ns0:
    v_exp_f32 v48, v48
    v_exp_f32 v49, v49
    v_exp_f32 v50, v50
    v_exp_f32 v51, v51
    s_waitcnt lgkmcnt(0)
    v_mfma_f32_32x32x16_bf16 v[64:79], v[24:27], v[8:11], 0
    v_exp_f32 v52, v52
    v_exp_f32 v53, v53
    v_exp_f32 v54, v54
    v_exp_f32 v55, v55
    v_mfma_f32_32x32x16_bf16 v[64:79], v[28:31], v[12:15], v[64:79]
    v_cvt_pk_bf16_f32 v80, v48, v49
    v_cvt_pk_bf16_f32 v81, v50, v51
    ds_read_b128 v[32:35], v115 offset:0
    ds_read_b128 v[36:39], v115 offset:608
    ds_read_b128 v[16:19], v113 offset:4992
    ds_read_b64 v[20:21], v114 offset:4992
    v_exp_f32 v56, v56
    v_exp_f32 v57, v57
    v_exp_f32 v58, v58
    v_exp_f32 v59, v59
    v_mfma_f32_32x32x16_bf16 v[96:111], v[40:43], v[88:91], v[96:111]
    v_cvt_pk_bf16_f32 v82, v52, v53
    v_cvt_pk_bf16_f32 v83, v54, v55
    v_exp_f32 v60, v60
    v_exp_f32 v61, v61
    v_exp_f32 v62, v62
    v_exp_f32 v63, v63
    v_mfma_f32_32x32x16_bf16 v[96:111], v[44:47], v[92:95], v[96:111]
    v_cvt_pk_bf16_f32 v84, v56, v57
    v_cvt_pk_bf16_f32 v85, v58, v59
    v_cvt_pk_bf16_f32 v86, v60, v61
    v_cvt_pk_bf16_f32 v87, v62, v63
    s_cmp_lg_u32 s27, 0
    s_cbranch_scc1 attn_ns1
    s_mov_b32 m0, s22
    s_add_u32 s22, s22, 8192
    buffer_load_dwordx4 v7, s[16:19], s23 offen lds
    s_add_u32 s23, s23, 8192
    s_mov_b32 m0, s22
    s_add_u32 s22, s22, 8192
    buffer_load_dwordx4 v7, s[16:19], s23 offen lds
    s_add_u32 s23, s23, 8192
attn_ns1:
    v_exp_f32 v64, v64
    v_exp_f32 v65, v65
    v_exp_f32 v66, v66
    v_exp_f32 v67, v67
    s_waitcnt lgkmcnt(0)
    v_mfma_f32_32x32x16_bf16 v[48:63], v[16:19], v[8:11], 0
    v_exp_f32 v68, v68
    v_exp_f32 v69, v69
    v_exp_f32 v70, v70
    v_exp_f32 v71, v71
    v_mfma_f32_32x32x16_bf16 v[48:63], v[20:23], v[12:15], v[48:63]
    v_cvt_pk_bf16_f32 v88, v64, v65
    v_cvt_pk_bf16_f32 v89, v66, v67
    ds_read_b128 v[40:43], v115 offset:2496
    ds_read_b128 v[44:47], v115 offset:3104
    ds_read_b128 v[24:27], v113 offset:7488
    ds_read_b64 v[28:29], v114 offset:7488
    v_exp_f32 v72, v72
    v_exp_f32 v73, v73
    v_exp_f32 v74, v74
    v_exp_f32 v75, v75
    v_mfma_f32_32x32x16_bf16 v[96:111], v[32:35], v[80:83], v[96:111]
    v_cvt_pk_bf16_f32 v90, v68, v69
    v_cvt_pk_bf16_f32 v91, v70, v71
    v_exp_f32 v76, v76
    v_exp_f32 v77, v77
    v_exp_f32 v78, v78
    v_exp_f32 v79, v79
    v_mfma_f32_32x32x16_bf16 v[96:111], v[36:39], v[84:87], v[96:111]
    v_cvt_pk_bf16_f32 v92, v72, v73
    v_cvt_pk_bf16_f32 v93, v74, v75
    v_cvt_pk_bf16_f32 v94, v76, v77
    v_cvt_pk_bf16_f32 v95, v78, v79
    s_cmp_lg_u32 s27, 0
    s_cbranch_scc1 attn_ns2
    s_mov_b32 m0, s22
    s_add_u32 s22, s22, 8192
    buffer_load_dwordx4 v7, s[16:19], s23 offen lds
    s_add_u32 s23, s23, 8192
    s_mov_b32 m0, s22
    s_add_u32 s22, s22, 8192
    buffer_load_dwordx4 v7, s[16:19], s23 offen lds
    s_add_u32 s23, s23, 8192
attn_ns2:
    v_exp_f32 v48, v48
    v_exp_f32 v49, v49
    v_exp_f32 v50, v50
    v_exp_f32 v51, v51
    s_waitcnt lgkmcnt(0)
    v_mfma_f32_32x32x16_bf16 v[64:79], v[24:27], v[8:11], 0
    v_exp_f32 v52, v52
    v_exp_f32 v53, v53
    v_exp_f32 v54, v54
    v_exp_f32 v55, v55
    v_mfma_f32_32x32x16_bf16 v[64:79], v[28:31], v[12:15], v[64:79]
    v_cvt_pk_bf16_f32 v80, v48, v49
    v_cvt_pk_bf16_f32 v81, v50, v51
    ds_read_b128 v[32:35], v115 offset:4992
    ds_read_b128 v[36:39], v115 offset:5600
    ds_read_b128 v[16:19], v113 offset:9984
    ds_read_b64 v[20:21], v114 offset:9984
    v_exp_f32 v56, v56
    v_exp_f32 v57, v57
    v_exp_f32 v58, v58
    v_exp_f32 v59, v59
    v_mfma_f32_32x32x16_bf16 v[96:111], v[40:43], v[88:91], v[96:111]
    v_cvt_pk_bf16_f32 v82, v52, v53
    v_cvt_pk_bf16_f32 v83, v54, v55
    v_exp_f32 v60, v60
    v_exp_f32 v61, v61
    v_exp_f32 v62, v62
    v_exp_f32 v63, v63
    v_mfma_f32_32x32x16_bf16 v[96:111], v[44:47], v[92:95], v[96:111]
    v_cvt_pk_bf16_f32 v84, v56, v57
    v_cvt_pk_bf16_f32 v85, v58, v59
    v_cvt_pk_bf16_f32 v86, v60, v61
    v_cvt_pk_bf16_f32 v87, v62, v63
    s_cmp_lg_u32 s27, 0
    s_cbranch_scc1 attn_ns3
    s_mov_b32 m0, s22
    s_add_u32 s22, s22, 8192
    buffer_load_dwordx4 v7, s[16:19], s23 offen lds
    s_add_u32 s23, s23, 8192
    s_mov_b32 m0, s22
    s_add_u32 s22, s22, 8192
    buffer_load_dwordx4 v7, s[16:19], s23 offen lds
    s_add_u32 s23, s23, 8192
attn_ns3:
    v_exp_f32 v64, v64
    v_exp_f32 v65, v65
    v_exp_f32 v66, v66
    v_exp_f32 v67, v67
    s_waitcnt lgkmcnt(0)
    v_mfma_f32_32x32x16_bf16 v[48:63], v[16:19], v[8:11], 0
    v_exp_f32 v68, v68
    v_exp_f32 v69, v69
    v_exp_f32 v70, v70
    v_exp_f32 v71, v71
    v_mfma_f32_32x32x16_bf16 v[48:63], v[20:23], v[12:15], v[48:63]
    v_cvt_pk_bf16_f32 v88, v64, v65
    v_cvt_pk_bf16_f32 v89, v66, v67
    ds_read_b128 v[40:43], v115 offset:7488
    ds_read_b128 v[44:47], v115 offset:8096
    ds_read_b128 v[24:27], v113 offset:12480
    ds_read_b64 v[28:29], v114 offset:12480
    v_exp_f32 v72, v72
    v_exp_f32 v73, v73
    v_exp_f32 v74, v74
    v_exp_f32 v75, v75
    v_mfma_f32_32x32x16_bf16 v[96:111], v[32:35], v[80:83], v[96:111]
    v_cvt_pk_bf16_f32 v90, v68, v69
    v_cvt_pk_bf16_f32 v91, v70, v71
    v_exp_f32 v76, v76
    v_exp_f32 v77, v77
    v_exp_f32 v78, v78
    v_exp_f32 v79, v79
    v_mfma_f32_32x32x16_bf16 v[96:111], v[36:39], v[84:87], v[96:111]
    v_cvt_pk_bf16_f32 v92, v72, v73
    v_cvt_pk_bf16_f32 v93, v74, v75
    v_cvt_pk_bf16_f32 v94, v76, v77
    v_cvt_pk_bf16_f32 v95, v78, v79
    s_cmp_lg_u32 s27, 0
    s_cbranch_scc1 attn_ns4
    s_waitcnt vmcnt(8)
    s_barrier
    s_mov_b32 m0, s22
    s_add_u32 s22, s22, 8192
    buffer_load_dwordx4 v7, s[16:19], s23 offen lds
    s_add_u32 s23, s23, 8192
    s_mov_b32 m0, s22
    s_add_u32 s22, s22, 8192
    buffer_load_dwordx4 v7, s[16:19], s23 offen lds
    s_add_u32 s23, s23, 8192
attn_ns4:
    v_exp_f32 v48, v48
    v_exp_f32 v49, v49
    v_exp_f32 v50, v50
    v_exp_f32 v51, v51
    s_waitcnt lgkmcnt(0)
    v_mfma_f32_32x32x16_bf16 v[64:79], v[24:27], v[8:11], 0
    v_exp_f32 v52, v52
    v_exp_f32 v53, v53
    v_exp_f32 v54, v54
    v_exp_f32 v55, v55
    v_mfma_f32_32x32x16_bf16 v[64:79], v[28:31], v[12:15], v[64:79]
    v_cvt_pk_bf16_f32 v80, v48, v49
    v_cvt_pk_bf16_f32 v81, v50, v51
    ds_read_b128 v[32:35], v115 offset:9984
    ds_read_b128 v[36:39], v115 offset:10592
    ds_read_b128 v[16:19], v113 offset:14976
    ds_read_b64 v[20:21], v114 offset:14976
    v_exp_f32 v56, v56
    v_exp_f32 v57, v57
    v_exp_f32 v58, v58
    v_exp_f32 v59, v59
    v_mfma_f32_32x32x16_bf16 v[96:111], v[40:43], v[88:91], v[96:111]
    v_cvt_pk_bf16_f32 v82, v52, v53
    v_cvt_pk_bf16_f32 v83, v54, v55
    v_exp_f32 v60, v60
    v_exp_f32 v61, v61
    v_exp_f32 v62, v62
    v_exp_f32 v63, v63
    v_mfma_f32_32x32x16_bf16 v[96:111], v[44:47], v[92:95], v[96:111]
    v_cvt_pk_bf16_f32 v84, v56, v57
    v_cvt_pk_bf16_f32 v85, v58, v59
    v_cvt_pk_bf16_f32 v86, v60, v61
    v_cvt_pk_bf16_f32 v87, v62, v63
    s_cmp_lg_u32 s27, 0
    s_cbranch_scc1 attn_ns5
    s_mov_b32 m0, s22
    s_add_u32 s22, s22, 8192
    buffer_load_dwordx4 v7, s[16:19], s23 offen lds
    s_add_u32 s23, s23, 8192
    s_mov_b32 m0, s22
    s_add_u32 s22, s22, 8192
    buffer_load_dwordx4 v7, s[16:19], s23 offen lds
    s_add_u32 s23, s23, 8192
attn_ns5:
    v_exp_f32 v64, v64
    v_exp_f32 v65, v65
    v_exp_f32 v66, v66
    v_exp_f32 v67, v67
    s_waitcnt lgkmcnt(0)
    v_mfma_f32_32x32x16_bf16 v[48:63], v[16:19], v[8:11], 0
    v_exp_f32 v68, v68
    v_exp_f32 v69, v69
    v_exp_f32 v70, v70
    v_exp_f32 v71, v71
    v_mfma_f32_32x32x16_bf16 v[48:63], v[20:23], v[12:15], v[48:63]
    v_cvt_pk_bf16_f32 v88, v64, v65
    v_cvt_pk_bf16_f32 v89, v66, v67
    ds_read_b128 v[40:43], v115 offset:12480
    ds_read_b128 v[44:47], v115 offset:13088
    ds_read_b128 v[24:27], v113 offset:17472
    ds_read_b64 v[28:29], v114 offset:17472
    v_exp_f32 v72, v72
    v_exp_f32 v73, v73
    v_exp_f32 v74, v74
    v_exp_f32 v75, v75
    v_mfma_f32_32x32x16_bf16 v[96:111], v[32:35], v[80:83], v[96:111]
    v_cvt_pk_bf16_f32 v90, v68, v69
    v_cvt_pk_bf16_f32 v91, v70, v71
    v_exp_f32 v76, v76
    v_exp_f32 v77, v77
    v_exp_f32 v78, v78
    v_exp_f32 v79, v79
    v_mfma_f32_32x32x16_bf16 v[96:111], v[36:39], v[84:87], v[96:111]
    v_cvt_pk_bf16_f32 v92, v72, v73
    v_cvt_pk_bf16_f32 v93, v74, v75
    v_cvt_pk_bf16_f32 v94, v76, v77
    v_cvt_pk_bf16_f32 v95, v78, v79
    s_cmp_lg_u32 s27, 0
    s_cbranch_scc1 attn_ns6
    s_mov_b32 m0, s22
    s_add_u32 s22, s22, 8192
    buffer_load_dwordx4 v7, s[16:19], s23 offen lds
    s_add_u32 s23, s23, 8192
    s_mov_b32 m0, s22
    s_add_u32 s22, s22, 8192
    buffer_load_dwordx4 v7, s[16:19], s23 offen lds
    s_add_u32 s23, s23, 8192
attn_ns6:
    v_exp_f32 v48, v48
    v_exp_f32 v49, v49
    v_exp_f32 v50, v50
    v_exp_f32 v51, v51
    s_waitcnt lgkmcnt(0)
    v_mfma_f32_32x32x16_bf16 v[64:79], v[24:27], v[8:11], 0
    v_exp_f32 v52, v52
    v_exp_f32 v53, v53
    v_exp_f32 v54, v54
    v_exp_f32 v55, v55
    v_mfma_f32_32x32x16_bf16 v[64:79], v[28:31], v[12:15], v[64:79]
    v_cvt_pk_bf16_f32 v80, v48, v49
    v_cvt_pk_bf16_f32 v81, v50, v51
    ds_read_b128 v[32:35], v115 offset:14976
    ds_read_b128 v[36:39], v115 offset:15584
    ds_read_b128 v[16:19], v113 offset:19968
    ds_read_b64 v[20:21], v114 offset:19968
    v_exp_f32 v56, v56
    v_exp_f32 v57, v57
    v_exp_f32 v58, v58
    v_exp_f32 v59, v59
    v_mfma_f32_32x32x16_bf16 v[96:111], v[40:43], v[88:91], v[96:111]
    v_cvt_pk_bf16_f32 v82, v52, v53
    v_cvt_pk_bf16_f32 v83, v54, v55
    v_exp_f32 v60, v60
    v_exp_f32 v61, v61
    v_exp_f32 v62, v62
    v_exp_f32 v63, v63
    v_mfma_f32_32x32x16_bf16 v[96:111], v[44:47], v[92:95], v[96:111]
    v_cvt_pk_bf16_f32 v84, v56, v57
    v_cvt_pk_bf16_f32 v85, v58, v59
    v_cvt_pk_bf16_f32 v86, v60, v61
    v_cvt_pk_bf16_f32 v87, v62, v63
    s_cmp_lg_u32 s27, 0
    s_cbranch_scc1 attn_ns7
    s_mov_b32 m0, s22
    s_add_u32 s22, s22, 8192
    buffer_load_dwordx4 v7, s[16:19], s23 offen lds
    s_add_u32 s23, s23, 8192
    s_cmp_ge_u32 s14, 4
    s_cbranch_scc1 attn_dmadonef
    s_mov_b32 m0, s22
    s_add_u32 s22, s22, 8192
    buffer_load_dwordx4 v7, s[16:19], s23 offen lds
    s_add_u32 s23, s23, 8192
attn_dmadonef:
attn_ns7:
    v_exp_f32 v64, v64
    v_exp_f32 v65, v65
    v_exp_f32 v66, v66
    v_exp_f32 v67, v67
    s_waitcnt lgkmcnt(0)
    v_mfma_f32_32x32x16_bf16 v[48:63], v[16:19], v[8:11], 0
    v_exp_f32 v68, v68
    v_exp_f32 v69, v69
    v_exp_f32 v70, v70
    v_exp_f32 v71, v71
    v_mfma_f32_32x32x16_bf16 v[48:63], v[20:23], v[12:15], v[48:63]
    v_cvt_pk_bf16_f32 v88, v64, v65
    v_cvt_pk_bf16_f32 v89, v66, v67
    ds_read_b128 v[40:43], v115 offset:17472
    ds_read_b128 v[44:47], v115 offset:18080
    ds_read_b128 v[24:27], v113 offset:22464
    ds_read_b64 v[28:29], v114 offset:22464
    v_exp_f32 v72, v72
    v_exp_f32 v73, v73
    v_exp_f32 v74, v74
    v_exp_f32 v75, v75
    v_mfma_f32_32x32x16_bf16 v[96:111], v[32:35], v[80:83], v[96:111]
    v_cvt_pk_bf16_f32 v90, v68, v69
    v_cvt_pk_bf16_f32 v91, v70, v71
    v_exp_f32 v76, v76
    v_exp_f32 v77, v77
    v_exp_f32 v78, v78
    v_exp_f32 v79, v79
    v_mfma_f32_32x32x16_bf16 v[96:111], v[36:39], v[84:87], v[96:111]
    v_cvt_pk_bf16_f32 v92, v72, v73
    v_cvt_pk_bf16_f32 v93, v74, v75
    v_cvt_pk_bf16_f32 v94, v76, v77
    v_cvt_pk_bf16_f32 v95, v78, v79
    v_exp_f32 v48, v48
    v_exp_f32 v49, v49
    v_exp_f32 v50, v50
    v_exp_f32 v51, v51
    s_waitcnt lgkmcnt(0)
    v_mfma_f32_32x32x16_bf16 v[64:79], v[24:27], v[8:11], 0
    v_exp_f32 v52, v52
    v_exp_f32 v53, v53
    v_exp_f32 v54, v54
    v_exp_f32 v55, v55
    v_mfma_f32_32x32x16_bf16 v[64:79], v[28:31], v[12:15], v[64:79]
    v_cvt_pk_bf16_f32 v80, v48, v49
    v_cvt_pk_bf16_f32 v81, v50, v51
    ds_read_b128 v[32:35], v115 offset:19968
    ds_read_b128 v[36:39], v115 offset:20576
    ds_read_b128 v[16:19], v113 offset:24960
    ds_read_b64 v[20:21], v114 offset:24960
    v_exp_f32 v56, v56
    v_exp_f32 v57, v57
    v_exp_f32 v58, v58
    v_exp_f32 v59, v59
    v_mfma_f32_32x32x16_bf16 v[96:111], v[40:43], v[88:91], v[96:111]
    v_cvt_pk_bf16_f32 v82, v52, v53
    v_cvt_pk_bf16_f32 v83, v54, v55
    v_exp_f32 v60, v60
    v_exp_f32 v61, v61
    v_exp_f32 v62, v62
    v_exp_f32 v63, v63
    v_mfma_f32_32x32x16_bf16 v[96:111], v[44:47], v[92:95], v[96:111]
    v_cvt_pk_bf16_f32 v84, v56, v57
    v_cvt_pk_bf16_f32 v85, v58, v59
    v_cvt_pk_bf16_f32 v86, v60, v61
    v_cvt_pk_bf16_f32 v87, v62, v63
    v_exp_f32 v64, v64
    v_exp_f32 v65, v65
    v_exp_f32 v66, v66
    v_exp_f32 v67, v67
    s_waitcnt lgkmcnt(0)
    v_mfma_f32_32x32x16_bf16 v[48:63], v[16:19], v[8:11], 0
    v_exp_f32 v68, v68
    v_exp_f32 v69, v69
    v_exp_f32 v70, v70
    v_exp_f32 v71, v71
    v_mfma_f32_32x32x16_bf16 v[48:63], v[20:23], v[12:15], v[48:63]
    v_cvt_pk_bf16_f32 v88, v64, v65
    v_cvt_pk_bf16_f32 v89, v66, v67
    ds_read_b128 v[40:43], v115 offset:22464
    ds_read_b128 v[44:47], v115 offset:23072
    ds_read_b128 v[24:27], v113 offset:27456
    ds_read_b64 v[28:29], v114 offset:27456
    v_exp_f32 v72, v72
    v_exp_f32 v73, v73
    v_exp_f32 v74, v74
    v_exp_f32 v75, v75
    v_mfma_f32_32x32x16_bf16 v[96:111], v[32:35], v[80:83], v[96:111]
    v_cvt_pk_bf16_f32 v90, v68, v69
    v_cvt_pk_bf16_f32 v91, v70, v71
    v_exp_f32 v76, v76
    v_exp_f32 v77, v77
    v_exp_f32 v78, v78
    v_exp_f32 v79, v79
    v_mfma_f32_32x32x16_bf16 v[96:111], v[36:39], v[84:87], v[96:111]
    v_cvt_pk_bf16_f32 v92, v72, v73
    v_cvt_pk_bf16_f32 v93, v74, v75
    v_cvt_pk_bf16_f32 v94, v76, v77
    v_cvt_pk_bf16_f32 v95, v78, v79
    v_exp_f32 v48, v48
    v_exp_f32 v49, v49
    v_exp_f32 v50, v50
    v_exp_f32 v51, v51
    s_waitcnt lgkmcnt(0)
    v_mfma_f32_32x32x16_bf16 v[64:79], v[24:27], v[8:11], 0
    v_exp_f32 v52, v52
    v_exp_f32 v53, v53
    v_exp_f32 v54, v54
    v_exp_f32 v55, v55
    v_mfma_f32_32x32x16_bf16 v[64:79], v[28:31], v[12:15], v[64:79]
    v_cvt_pk_bf16_f32 v80, v48, v49
    v_cvt_pk_bf16_f32 v81, v50, v51
    ds_read_b128 v[32:35], v115 offset:24960
    ds_read_b128 v[36:39], v115 offset:25568
    ds_read_b128 v[16:19], v113 offset:29952
    ds_read_b64 v[20:21], v114 offset:29952
    v_exp_f32 v56, v56
    v_exp_f32 v57, v57
    v_exp_f32 v58, v58
    v_exp_f32 v59, v59
    v_mfma_f32_32x32x16_bf16 v[96:111], v[40:43], v[88:91], v[96:111]
    v_cvt_pk_bf16_f32 v82, v52, v53
    v_cvt_pk_bf16_f32 v83, v54, v55
    v_exp_f32 v60, v60
    v_exp_f32 v61, v61
    v_exp_f32 v62, v62
    v_exp_f32 v63, v63
    v_mfma_f32_32x32x16_bf16 v[96:111], v[44:47], v[92:95], v[96:111]
    v_cvt_pk_bf16_f32 v84, v56, v57
    v_cvt_pk_bf16_f32 v85, v58, v59
    v_cvt_pk_bf16_f32 v86, v60, v61
    v_cvt_pk_bf16_f32 v87, v62, v63
    s_cmp_lg_u32 s27, 0
    s_cbranch_scc1 attn_ns11
    s_waitcnt vmcnt(11)
    s_barrier
attn_ns11:
    v_exp_f32 v64, v64
    v_exp_f32 v65, v65
    v_exp_f32 v66, v66
    v_exp_f32 v67, v67
    s_waitcnt lgkmcnt(0)
    v_mfma_f32_32x32x16_bf16 v[48:63], v[16:19], v[8:11], 0
    v_exp_f32 v68, v68
    v_exp_f32 v69, v69
    v_exp_f32 v70, v70
    v_exp_f32 v71, v71
    v_mfma_f32_32x32x16_bf16 v[48:63], v[20:23], v[12:15], v[48:63]
    v_cvt_pk_bf16_f32 v88, v64, v65
    v_cvt_pk_bf16_f32 v89, v66, v67
    ds_read_b128 v[40:43], v115 offset:27456
    ds_read_b128 v[44:47], v115 offset:28064
    ds_read_b128 v[24:27], v113 offset:32448
    ds_read_b64 v[28:29], v114 offset:32448
    v_exp_f32 v72, v72
    v_exp_f32 v73, v73
    v_exp_f32 v74, v74
    v_exp_f32 v75, v75
    v_mfma_f32_32x32x16_bf16 v[96:111], v[32:35], v[80:83], v[96:111]
    v_cvt_pk_bf16_f32 v90, v68, v69
    v_cvt_pk_bf16_f32 v91, v70, v71
    v_exp_f32 v76, v76
    v_exp_f32 v77, v77
    v_exp_f32 v78, v78
    v_exp_f32 v79, v79
    v_mfma_f32_32x32x16_bf16 v[96:111], v[36:39], v[84:87], v[96:111]
    v_cvt_pk_bf16_f32 v92, v72, v73
    v_cvt_pk_bf16_f32 v93, v74, v75
    v_cvt_pk_bf16_f32 v94, v76, v77
    v_cvt_pk_bf16_f32 v95, v78, v79
    v_exp_f32 v48, v48
    v_exp_f32 v49, v49
    v_exp_f32 v50, v50
    v_exp_f32 v51, v51
    s_waitcnt lgkmcnt(0)
    v_mfma_f32_32x32x16_bf16 v[64:79], v[24:27], v[8:11], 0
    v_exp_f32 v52, v52
    v_exp_f32 v53, v53
    v_exp_f32 v54, v54
    v_exp_f32 v55, v55
    v_mfma_f32_32x32x16_bf16 v[64:79], v[28:31], v[12:15], v[64:79]
    v_cvt_pk_bf16_f32 v80, v48, v49
    v_cvt_pk_bf16_f32 v81, v50, v51
    ds_read_b128 v[32:35], v115 offset:29952
    ds_read_b128 v[36:39], v115 offset:30560
    ds_read_b128 v[16:19], v113 offset:34944
    ds_read_b64 v[20:21], v114 offset:34944
    v_exp_f32 v56, v56
    v_exp_f32 v57, v57
    v_exp_f32 v58, v58
    v_exp_f32 v59, v59
    v_mfma_f32_32x32x16_bf16 v[96:111], v[40:43], v[88:91], v[96:111]
    v_cvt_pk_bf16_f32 v82, v52, v53
    v_cvt_pk_bf16_f32 v83, v54, v55
    v_exp_f32 v60, v60
    v_exp_f32 v61, v61
    v_exp_f32 v62, v62
    v_exp_f32 v63, v63
    v_mfma_f32_32x32x16_bf16 v[96:111], v[44:47], v[92:95], v[96:111]
    v_cvt_pk_bf16_f32 v84, v56, v57
    v_cvt_pk_bf16_f32 v85, v58, v59
    v_cvt_pk_bf16_f32 v86, v60, v61
    v_cvt_pk_bf16_f32 v87, v62, v63
    v_exp_f32 v64, v64
    v_exp_f32 v65, v65
    v_exp_f32 v66, v66
    v_exp_f32 v67, v67
    s_waitcnt lgkmcnt(0)
    v_mfma_f32_32x32x16_bf16 v[48:63], v[16:19], v[8:11], 0
    v_exp_f32 v68, v68
    v_exp_f32 v69, v69
    v_exp_f32 v70, v70
    v_exp_f32 v71, v71
    v_mfma_f32_32x32x16_bf16 v[48:63], v[20:23], v[12:15], v[48:63]
    v_cvt_pk_bf16_f32 v88, v64, v65
    v_cvt_pk_bf16_f32 v89, v66, v67
    ds_read_b128 v[40:43], v115 offset:32448
    ds_read_b128 v[44:47], v115 offset:33056
    ds_read_b128 v[24:27], v113 offset:37440
    ds_read_b64 v[28:29], v114 offset:37440
    v_exp_f32 v72, v72
    v_exp_f32 v73, v73
    v_exp_f32 v74, v74
    v_exp_f32 v75, v75
    v_mfma_f32_32x32x16_bf16 v[96:111], v[32:35], v[80:83], v[96:111]
    v_cvt_pk_bf16_f32 v90, v68, v69
    v_cvt_pk_bf16_f32 v91, v70, v71
    v_exp_f32 v76, v76
    v_exp_f32 v77, v77
    v_exp_f32 v78, v78
    v_exp_f32 v79, v79
    v_mfma_f32_32x32x16_bf16 v[96:111], v[36:39], v[84:87], v[96:111]
    v_cvt_pk_bf16_f32 v92, v72, v73
    v_cvt_pk_bf16_f32 v93, v74, v75
    v_cvt_pk_bf16_f32 v94, v76, v77
    v_cvt_pk_bf16_f32 v95, v78, v79
    v_exp_f32 v48, v48
    v_exp_f32 v49, v49
    v_exp_f32 v50, v50
    v_exp_f32 v51, v51
    s_waitcnt lgkmcnt(0)
    v_mfma_f32_32x32x16_bf16 v[64:79], v[24:27], v[8:11], 0
    v_exp_f32 v52, v52
    v_exp_f32 v53, v53
    v_exp_f32 v54, v54
    v_exp_f32 v55, v55
    v_mfma_f32_32x32x16_bf16 v[64:79], v[28:31], v[12:15], v[64:79]
    v_cvt_pk_bf16_f32 v80, v48, v49
    v_cvt_pk_bf16_f32 v81, v50, v51
    ds_read_b128 v[32:35], v115 offset:34944
    ds_read_b128 v[36:39], v115 offset:35552
    ds_read_b128 v[16:19], v113 offset:39936
    ds_read_b64 v[20:21], v114 offset:39936
    v_exp_f32 v56, v56
    v_exp_f32 v57, v57
    v_exp_f32 v58, v58
    v_exp_f32 v59, v59
    v_mfma_f32_32x32x16_bf16 v[96:111], v[40:43], v[88:91], v[96:111]
    v_cvt_pk_bf16_f32 v82, v52, v53
    v_cvt_pk_bf16_f32 v83, v54, v55
    v_exp_f32 v60, v60
    v_exp_f32 v61, v61
    v_exp_f32 v62, v62
    v_exp_f32 v63, v63
    v_mfma_f32_32x32x16_bf16 v[96:111], v[44:47], v[92:95], v[96:111]
    v_cvt_pk_bf16_f32 v84, v56, v57
    v_cvt_pk_bf16_f32 v85, v58, v59
    v_cvt_pk_bf16_f32 v86, v60, v61
    v_cvt_pk_bf16_f32 v87, v62, v63
    v_exp_f32 v64, v64
    v_exp_f32 v65, v65
    v_exp_f32 v66, v66
    v_exp_f32 v67, v67
    s_waitcnt lgkmcnt(0)
    v_mfma_f32_32x32x16_bf16 v[48:63], v[16:19], v[8:11], 0
    v_exp_f32 v68, v68
    v_exp_f32 v69, v69
    v_exp_f32 v70, v70
    v_exp_f32 v71, v71
    v_mfma_f32_32x32x16_bf16 v[48:63], v[20:23], v[12:15], v[48:63]
    v_cvt_pk_bf16_f32 v88, v64, v65
    v_cvt_pk_bf16_f32 v89, v66, v67
    ds_read_b128 v[40:43], v115 offset:37440
    ds_read_b128 v[44:47], v115 offset:38048
    ds_read_b128 v[24:27], v113 offset:42432
    ds_read_b64 v[28:29], v114 offset:42432
    v_exp_f32 v72, v72
    v_exp_f32 v73, v73
    v_exp_f32 v74, v74
    v_exp_f32 v75, v75
    v_mfma_f32_32x32x16_bf16 v[96:111], v[32:35], v[80:83], v[96:111]
    v_cvt_pk_bf16_f32 v90, v68, v69
    v_cvt_pk_bf16_f32 v91, v70, v71
    v_exp_f32 v76, v76
    v_exp_f32 v77, v77
    v_exp_f32 v78, v78
    v_exp_f32 v79, v79
    v_mfma_f32_32x32x16_bf16 v[96:111], v[36:39], v[84:87], v[96:111]
    v_cvt_pk_bf16_f32 v92, v72, v73
    v_cvt_pk_bf16_f32 v93, v74, v75
    v_cvt_pk_bf16_f32 v94, v76, v77
    v_cvt_pk_bf16_f32 v95, v78, v79
    v_add_u32 v113, 39936, v113
    v_add_u32 v114, 39936, v114
    v_add_u32 v115, 39936, v115
    s_add_u32 s24, s24, 1
    s_cmp_lg_u32 s24, 4
    s_cbranch_scc1 attn_main
    s_waitcnt lgkmcnt(0)
    v_mfma_f32_32x32x16_bf16 v[96:111], v[40:43], v[88:91], v[96:111]
    v_mfma_f32_32x32x16_bf16 v[96:111], v[44:47], v[92:95], v[96:111]
    s_nop 7
    s_nop 7
    v_rcp_f32 v117, v106
    s_add_u32 s21, s20, 8388608
    v_lshl_add_u32 v6, v4, 3, v5
    v_mul_f32 v96, v96, v117
    v_mul_f32 v97, v97, v117
    v_mul_f32 v98, v98, v117
    v_mul_f32 v99, v99, v117
    v_mul_f32 v100, v100, v117
    v_mul_f32 v101, v101, v117
    v_mul_f32 v102, v102, v117
    v_mul_f32 v103, v103, v117
    v_mul_f32 v104, v104, v117
    v_mul_f32 v105, v105, v117
    v_cvt_pk_bf16_f32 v80, v96, v97
    v_cvt_pk_bf16_f32 v81, v98, v99
    v_cvt_pk_bf16_f32 v82, v100, v101
    v_cvt_pk_bf16_f32 v83, v102, v103
    v_cvt_pk_bf16_f32 v84, v104, v105
    buffer_store_dwordx2 v[80:81], v6, s[16:19], s21 offen
    buffer_store_dwordx2 v[82:83], v6, s[16:19], s21 offen offset:16
    s_and_saveexec_b64 s[32:33], s[30:31]
    buffer_store_dword v84, v5, s[16:19], s21 offen offset:32
    s_mov_b64 exec, -1
attn_end:
    s_endpgm
.globl oa0_kernel
.type oa0_kernel,@function
.p2align 8
oa0_kernel:
    s_cmp_ge_u32 s2, 256
    s_cbranch_scc1 oa0_end
    s_load_dwordx2 s[4:5], s[0:1], 80
    s_load_dwordx2 s[6:7], s[0:1], 80
    s_load_dwordx2 s[8:9], s[0:1], 0
    s_load_dwordx2 s[10:11], s[0:1], 80
    s_and_b32 s12, s2, 63
    s_lshr_b32 s13, s2, 6
    v_lshrrev_b32 v1, 6, v0
    v_and_b32 v2, 63, v0
    v_and_b32 v3, 15, v2
    v_readfirstlane_b32 s14, v1
    v_lshrrev_b32 v4, 4, v2
    v_mul_u32_u24 v5, 1152, v3
    v_lshl_add_u32 v5, v4, 4, v5
    v_lshlrev_b32 v6, 4, v2
    s_mul_i32 s15, s12, 36864
    s_lshl_b32 s26, s12, 5
    s_waitcnt lgkmcnt(0)
    s_add_u32 s16, s4, 8388608
    s_addc_u32 s17, s5, 0
    s_mov_b32 s18, 2359296
    s_mov_b32 s19, 0x00020000
    s_mov_b32 s20, s6
    s_mov_b32 s21, s7
    s_mov_b32 s22, 268435456
    s_mov_b32 s23, 0x00020000
    s_mov_b32 s40, s14
    s_mul_i32 s41, s40, 57
    s_lshr_b32 s41, s41, 10
    s_mul_i32 s42, s41, 18
    s_sub_u32 s42, s40, s42
    s_lshl_b32 s42, s42, 6
    s_mul_i32 s41, s41, 18432
    s_add_u32 s42, s42, s41
    s_add_u32 s42, s42, s15
    s_lshl_b32 s43, s40, 10
    s_mov_b32 m0, s43
    s_add_u32 s40, s40, 9
    buffer_load_dwordx4 v5, s[16:19], s42 offen lds
    s_mul_i32 s41, s40, 57
    s_lshr_b32 s41, s41, 10
    s_mul_i32 s42, s41, 18
    s_sub_u32 s42, s40, s42
    s_lshl_b32 s42, s42, 6
    s_mul_i32 s41, s41, 18432
    s_add_u32 s42, s42, s41
    s_add_u32 s42, s42, s15
    s_lshl_b32 s43, s40, 10
    s_mov_b32 m0, s43
    s_add_u32 s40, s40, 9
    buffer_load_dwordx4 v5, s[16:19], s42 offen lds
    s_mul_i32 s41, s40, 57
    s_lshr_b32 s41, s41, 10
    s_mul_i32 s42, s41, 18
    s_sub_u32 s42, s40, s42
    s_lshl_b32 s42, s42, 6
    s_mul_i32 s41, s41, 18432
    s_add_u32 s42, s42, s41
    s_add_u32 s42, s42, s15
    s_lshl_b32 s43, s40, 10
    s_mov_b32 m0, s43
    s_add_u32 s40, s40, 9
    buffer_load_dwordx4 v5, s[16:19], s42 offen lds
    s_mul_i32 s41, s40, 57
    s_lshr_b32 s41, s41, 10
    s_mul_i32 s42, s41, 18
    s_sub_u32 s42, s40, s42
    s_lshl_b32 s42, s42, 6
    s_mul_i32 s41, s41, 18432
    s_add_u32 s42, s42, s41
    s_add_u32 s42, s42, s15
    s_lshl_b32 s43, s40, 10
    s_mov_b32 m0, s43
    s_add_u32 s40, s40, 9
    buffer_load_dwordx4 v5, s[16:19], s42 offen lds
oa0_dmadone:
    s_barrier
    s_mul_i32 s24, s13, 9
    s_add_u32 s24, s24, s14
    s_mul_i32 s25, s24, 18432
    s_add_u32 s25, s25, 786432
    buffer_load_dwordx4 v[56:59], v6, s[20:23], s25 offen offset:0
    buffer_load_dwordx4 v[60:63], v6, s[20:23], s25 offen offset:1024
    buffer_load_dwordx4 v[64:67], v6, s[20:23], s25 offen offset:2048
    buffer_load_dwordx4 v[68:71], v6, s[20:23], s25 offen offset:3072
    s_add_u32 s25, s25, 4096
    buffer_load_dwordx4 v[72:75], v6, s[20:23], s25 offen offset:0
    buffer_load_dwordx4 v[76:79], v6, s[20:23], s25 offen offset:1024
    buffer_load_dwordx4 v[80:83], v6, s[20:23], s25 offen offset:2048
    buffer_load_dwordx4 v[84:87], v6, s[20:23], s25 offen offset:3072
    s_add_u32 s25, s25, 4096
    buffer_load_dwordx4 v[88:91], v6, s[20:23], s25 offen offset:0
    v_add_u32 v7, s26, v3
    s_lshl_b32 s27, s24, 4
    v_lshl_add_u32 v10, v4, 2, s27
    v_mul_u32_u24 v8, 1152, v7
    v_lshl_add_u32 v8, v10, 1, v8
    v_add_u32 v9, 18432, v8
    s_mov_b32 s28, s8
    s_mov_b32 s29, s9
    s_mov_b32 s30, 2359296
    s_mov_b32 s31, 0x00020000
    s_add_u32 s32, s10, 11534336
    s_addc_u32 s33, s11, 0
    s_mov_b32 s34, 2359296
    s_mov_b32 s35, 0x00020000
    buffer_load_dwordx2 v[148:149], v8, s[28:31], 0 offen
    buffer_load_dwordx2 v[150:151], v9, s[28:31], 0 offen
    s_waitcnt vmcnt(11)
    s_barrier
    v_mov_b32 v48, 0
    v_mov_b32 v49, 0
    v_mov_b32 v50, 0
    v_mov_b32 v51, 0
    v_mov_b32 v52, 0
    v_mov_b32 v53, 0
    v_mov_b32 v54, 0
    v_mov_b32 v55, 0
    ds_read_b128 v[16:19], v6 offset:0
    ds_read_b128 v[20:23], v6 offset:18432
    ds_read_b128 v[24:27], v6 offset:1024
    ds_read_b128 v[28:31], v6 offset:19456
    ds_read_b128 v[32:35], v6 offset:2048
    ds_read_b128 v[36:39], v6 offset:20480
    ds_read_b128 v[40:43], v6 offset:3072
    ds_read_b128 v[44:47], v6 offset:21504
    buffer_load_dwordx4 v[92:95], v6, s[20:23], s25 offen offset:1024
    s_waitcnt vmcnt(11) lgkmcnt(6)
    v_mfma_f32_16x16x32_bf16 v[48:51], v[56:59], v[16:19], v[48:51]
    v_mfma_f32_16x16x32_bf16 v[52:55], v[56:59], v[20:23], v[52:55]
    ds_read_b128 v[16:19], v6 offset:4096
    ds_read_b128 v[20:23], v6 offset:22528
    buffer_load_dwordx4 v[96:99], v6, s[20:23], s25 offen offset:2048
    s_waitcnt vmcnt(11) lgkmcnt(6)
    v_mfma_f32_16x16x32_bf16 v[48:51], v[60:63], v[24:27], v[48:51]
    v_mfma_f32_16x16x32_bf16 v[52:55], v[60:63], v[28:31], v[52:55]
    ds_read_b128 v[24:27], v6 offset:5120
    ds_read_b128 v[28:31], v6 offset:23552
    buffer_load_dwordx4 v[100:103], v6, s[20:23], s25 offen offset:3072
    s_waitcnt vmcnt(11) lgkmcnt(6)
    v_mfma_f32_16x16x32_bf16 v[48:51], v[64:67], v[32:35], v[48:51]
    v_mfma_f32_16x16x32_bf16 v[52:55], v[64:67], v[36:39], v[52:55]
    ds_read_b128 v[32:35], v6 offset:6144
    ds_read_b128 v[36:39], v6 offset:24576
    s_add_u32 s25, s25, 4096
    buffer_load_dwordx4 v[104:107], v6, s[20:23], s25 offen offset:0
    s_waitcnt vmcnt(11) lgkmcnt(6)
    v_mfma_f32_16x16x32_bf16 v[48:51], v[68:71], v[40:43], v[48:51]
    v_mfma_f32_16x16x32_bf16 v[52:55], v[68:71], v[44:47], v[52:55]
    ds_read_b128 v[40:43], v6 offset:7168
    ds_read_b128 v[44:47], v6 offset:25600
    buffer_load_dwordx4 v[108:111], v6, s[20:23], s25 offen offset:1024
    s_waitcnt vmcnt(11) lgkmcnt(6)
    v_mfma_f32_16x16x32_bf16 v[48:51], v[72:75], v[16:19], v[48:51]
    v_mfma_f32_16x16x32_bf16 v[52:55], v[72:75], v[20:23], v[52:55]
    ds_read_b128 v[16:19], v6 offset:8192
    ds_read_b128 v[20:23], v6 offset:26624
    buffer_load_dwordx4 v[112:115], v6, s[20:23], s25 offen offset:2048
    s_waitcnt vmcnt(11) lgkmcnt(6)
    v_mfma_f32_16x16x32_bf16 v[48:51], v[76:79], v[24:27], v[48:51]
    v_mfma_f32_16x16x32_bf16 v[52:55], v[76:79], v[28:31], v[52:55]
    ds_read_b128 v[24:27], v6 offset:9216
    ds_read_b128 v[28:31], v6 offset:27648
    buffer_load_dwordx4 v[116:119], v6, s[20:23], s25 offen offset:3072
    s_waitcnt vmcnt(11) lgkmcnt(6)
    v_mfma_f32_16x16x32_bf16 v[48:51], v[80:83], v[32:35], v[48:51]
    v_mfma_f32_16x16x32_bf16 v[52:55], v[80:83], v[36:39], v[52:55]
    ds_read_b128 v[32:35], v6 offset:10240
    ds_read_b128 v[36:39], v6 offset:28672
    s_add_u32 s25, s25, 4096
    buffer_load_dwordx4 v[120:123], v6, s[20:23], s25 offen offset:0
    s_waitcnt vmcnt(11) lgkmcnt(6)
    v_mfma_f32_16x16x32_bf16 v[48:51], v[84:87], v[40:43], v[48:51]
    v_mfma_f32_16x16x32_bf16 v[52:55], v[84:87], v[44:47], v[52:55]
    ds_read_b128 v[40:43], v6 offset:11264
    ds_read_b128 v[44:47], v6 offset:29696
    buffer_load_dwordx4 v[124:127], v6, s[20:23], s25 offen offset:1024
    s_waitcnt vmcnt(11) lgkmcnt(6)
    v_mfma_f32_16x16x32_bf16 v[48:51], v[88:91], v[16:19], v[48:51]
    v_mfma_f32_16x16x32_bf16 v[52:55], v[88:91], v[20:23], v[52:55]
    ds_read_b128 v[16:19], v6 offset:12288
    ds_read_b128 v[20:23], v6 offset:30720
    s_waitcnt vmcnt(8) lgkmcnt(6)
    v_mfma_f32_16x16x32_bf16 v[48:51], v[92:95], v[24:27], v[48:51]
    v_mfma_f32_16x16x32_bf16 v[52:55], v[92:95], v[28:31], v[52:55]
    ds_read_b128 v[24:27], v6 offset:13312
    ds_read_b128 v[28:31], v6 offset:31744
    s_waitcnt vmcnt(7) lgkmcnt(6)
    v_mfma_f32_16x16x32_bf16 v[48:51], v[96:99], v[32:35], v[48:51]
    v_mfma_f32_16x16x32_bf16 v[52:55], v[96:99], v[36:39], v[52:55]
    ds_read_b128 v[32:35], v6 offset:14336
    ds_read_b128 v[36:39], v6 offset:32768
    s_waitcnt vmcnt(6) lgkmcnt(6)
    v_mfma_f32_16x16x32_bf16 v[48:51], v[100:103], v[40:43], v[48:51]
    v_mfma_f32_16x16x32_bf16 v[52:55], v[100:103], v[44:47], v[52:55]
    ds_read_b128 v[40:43], v6 offset:15360
    ds_read_b128 v[44:47], v6 offset:33792
    s_waitcnt vmcnt(5) lgkmcnt(6)
    v_mfma_f32_16x16x32_bf16 v[48:51], v[104:107], v[16:19], v[48:51]
    v_mfma_f32_16x16x32_bf16 v[52:55], v[104:107], v[20:23], v[52:55]
    ds_read_b128 v[16:19], v6 offset:16384
    ds_read_b128 v[20:23], v6 offset:34816
    s_waitcnt vmcnt(4) lgkmcnt(6)
    v_mfma_f32_16x16x32_bf16 v[48:51], v[108:111], v[24:27], v[48:51]
    v_mfma_f32_16x16x32_bf16 v[52:55], v[108:111], v[28:31], v[52:55]
    ds_read_b128 v[24:27], v6 offset:17408
    ds_read_b128 v[28:31], v6 offset:35840
    s_waitcnt vmcnt(3) lgkmcnt(6)
    v_mfma_f32_16x16x32_bf16 v[48:51], v[112:115], v[32:35], v[48:51]
    v_mfma_f32_16x16x32_bf16 v[52:55], v[112:115], v[36:39], v[52:55]
    s_waitcnt vmcnt(2) lgkmcnt(4)
    v_mfma_f32_16x16x32_bf16 v[48:51], v[116:119], v[40:43], v[48:51]
    v_mfma_f32_16x16x32_bf16 v[52:55], v[116:119], v[44:47], v[52:55]
    s_waitcnt vmcnt(1) lgkmcnt(2)
    v_mfma_f32_16x16x32_bf16 v[48:51], v[120:123], v[16:19], v[48:51]
    v_mfma_f32_16x16x32_bf16 v[52:55], v[120:123], v[20:23], v[52:55]
    s_waitcnt vmcnt(0) lgkmcnt(0)
    v_mfma_f32_16x16x32_bf16 v[48:51], v[124:127], v[24:27], v[48:51]
    v_mfma_f32_16x16x32_bf16 v[52:55], v[124:127], v[28:31], v[52:55]
    s_waitcnt vmcnt(0)
    s_nop 7
    v_mov_b32 v159, 0x3f803f80
    v_cvt_pk_bf16_f32 v152, v48, v49
    v_cvt_pk_bf16_f32 v153, v50, v51
    v_lshlrev_b32 v154, 16, v152
    v_and_b32 v155, 0xffff0000, v152
    v_lshlrev_b32 v156, 16, v153
    v_and_b32 v157, 0xffff0000, v153
    v_lshlrev_b32 v158, 16, v148
    v_and_b32 v152, 0xffff0000, v148
    v_add_f32 v154, v154, v158
    v_add_f32 v155, v155, v152
    v_lshlrev_b32 v158, 16, v149
    v_and_b32 v152, 0xffff0000, v149
    v_add_f32 v156, v156, v158
    v_add_f32 v157, v157, v152
    v_cvt_pk_bf16_f32 v148, v154, v155
    v_cvt_pk_bf16_f32 v149, v156, v157
    buffer_store_dwordx2 v[148:149], v8, s[32:35], 0 offen
    v_dot2_f32_bf16 v128, v148, v159, 0
    v_dot2_f32_bf16 v129, v148, v148, 0
    v_dot2_f32_bf16 v128, v149, v159, v128
    v_dot2_f32_bf16 v129, v149, v149, v129
    v_cvt_pk_bf16_f32 v152, v52, v53
    v_cvt_pk_bf16_f32 v153, v54, v55
    v_lshlrev_b32 v154, 16, v152
    v_and_b32 v155, 0xffff0000, v152
    v_lshlrev_b32 v156, 16, v153
    v_and_b32 v157, 0xffff0000, v153
    v_lshlrev_b32 v158, 16, v150
    v_and_b32 v152, 0xffff0000, v150
    v_add_f32 v154, v154, v158
    v_add_f32 v155, v155, v152
    v_lshlrev_b32 v158, 16, v151
    v_and_b32 v152, 0xffff0000, v151
    v_add_f32 v156, v156, v158
    v_add_f32 v157, v157, v152
    v_cvt_pk_bf16_f32 v150, v154, v155
    v_cvt_pk_bf16_f32 v151, v156, v157
    buffer_store_dwordx2 v[150:151], v9, s[32:35], 0 offen
    v_dot2_f32_bf16 v130, v150, v159, 0
    v_dot2_f32_bf16 v131, v150, v150, 0
    v_dot2_f32_bf16 v130, v151, v159, v130
    v_dot2_f32_bf16 v131, v151, v151, v131
    s_nop 2
    v_mov_b32 v152, v128
    s_nop 1
    v_permlane16_swap_b32 v128, v152
    v_add_f32 v128, v128, v152
    v_mov_b32 v152, v128
    s_nop 1
    v_permlane32_swap_b32 v128, v152
    v_add_f32 v128, v128, v152
    v_mov_b32 v152, v129
    s_nop 1
    v_permlane16_swap_b32 v129, v152
    v_add_f32 v129, v129, v152
    v_mov_b32 v152, v129
    s_nop 1
    v_permlane32_swap_b32 v129, v152
    v_add_f32 v129, v129, v152
    v_mov_b32 v152, v130
    s_nop 1
    v_permlane16_swap_b32 v130, v152
    v_add_f32 v130, v130, v152
    v_mov_b32 v152, v130
    s_nop 1
    v_permlane32_swap_b32 v130, v152
    v_add_f32 v130, v130, v152
    v_mov_b32 v152, v131
    s_nop 1
    v_permlane16_swap_b32 v131, v152
    v_add_f32 v131, v131, v152
    v_mov_b32 v152, v131
    s_nop 1
    v_permlane32_swap_b32 v131, v152
    v_add_f32 v131, v131, v152
    s_lshl_b32 s27, s14, 8
    v_lshl_add_u32 v11, v3, 3, s27
    s_mov_b64 exec, 0xffff
    ds_write_b64 v11, v[128:129] offset:36864
    ds_write_b64 v11, v[130:131] offset:36992
    s_mov_b64 exec, -1
    s_waitcnt lgkmcnt(0)
    s_barrier
    s_cmp_lg_u32 s14, 0
    s_cbranch_scc1 oa0_fin
    v_lshlrev_b32 v11, 3, v2
    ds_read_b64 v[56:57], v11 offset:36864
    ds_read_b64 v[58:59], v11 offset:37120
    ds_read_b64 v[60:61], v11 offset:37376
    ds_read_b64 v[62:63], v11 offset:37632
    ds_read_b64 v[64:65], v11 offset:37888
    ds_read_b64 v[66:67], v11 offset:38144
    ds_read_b64 v[68:69], v11 offset:38400
    ds_read_b64 v[70:71], v11 offset:38656
    ds_read_b64 v[72:73], v11 offset:38912
    s_waitcnt lgkmcnt(0)
    v_add_f32 v56, v56, v58
    v_add_f32 v57, v57, v59
    v_add_f32 v56, v56, v60
    v_add_f32 v57, v57, v61
    v_add_f32 v56, v56, v62
    v_add_f32 v57, v57, v63
    v_add_f32 v56, v56, v64
    v_add_f32 v57, v57, v65
    v_add_f32 v56, v56, v66
    v_add_f32 v57, v57, v67
    v_add_f32 v56, v56, v68
    v_add_f32 v57, v57, v69
    v_add_f32 v56, v56, v70
    v_add_f32 v57, v57, v71
    v_add_f32 v56, v56, v72
    v_add_f32 v57, v57, v73
    v_add_u32 v11, s26, v2
    v_lshlrev_b32 v11, 5, v11
    s_lshl_b32 s27, s13, 3
    s_add_u32 s27, s27, 4849664
    s_mov_b32 exec_lo, -1
    s_mov_b32 exec_hi, 0
    buffer_store_dwordx2 v[56:57], v11, s[20:23], s27 offen
    s_mov_b64 exec, -1
oa0_fin:
oa0_end:
    s_endpgm
.globl qkvb0_kernel
.type qkvb0_kernel,@function
.p2align 8
qkvb0_kernel:
    s_cmp_ge_u32 s2, 256
    s_cbranch_scc1 qkvb0_end
    s_load_dwordx2 s[4:5], s[0:1], 80
    s_load_dwordx2 s[6:7], s[0:1], 80
    s_and_b32 s12, s2, 31
    s_lshr_b32 s13, s2, 5
    v_lshrrev_b32 v1, 6, v0
    v_and_b32 v2, 63, v0
    v_and_b32 v7, 15, v2
    v_readfirstlane_b32 s14, v1
    v_lshrrev_b32 v3, 2, v2
    v_and_b32 v4, 3, v2
    v_lshrrev_b32 v8, 4, v2
    v_lshlrev_b32 v6, 4, v2
    s_lshl_b32 s26, s12, 6
    s_sub_u32 s26, s26, 16
    s_waitcnt lgkmcnt(0)
    s_add_u32 s16, s4, 11534336
    s_addc_u32 s17, s5, 0
    s_mov_b32 s18, 2359296
    s_mov_b32 s19, 0x00020000
    s_mov_b32 s20, s6
    s_mov_b32 s21, s7
    s_mov_b32 s22, 268435456
    s_mov_b32 s23, 0x00020000
    s_cmp_ge_u32 s14, 2
    s_cbranch_scc1 qkvb0_nost
    v_min_u32 v11, 79, v0
    v_add_u32 v11, s26, v11
    v_max_i32 v11, 0, v11
    v_lshlrev_b32 v11, 5, v11
    v_add_u32 v11, 4849664, v11
    buffer_load_dwordx4 v[56:59], v11, s[20:23], 0 offen
    buffer_load_dwordx4 v[60:63], v11, s[20:23], 0 offen offset:16
qkvb0_nost:
    v_mul_u32_u24 v5, 1152, v7
    v_lshl_add_u32 v5, v8, 4, v5
    s_mov_b32 s40, s14
    s_mul_i32 s41, s40, 205
    s_lshr_b32 s41, s41, 10
    s_mul_i32 s42, s41, 5
    s_sub_u32 s42, s40, s42
    s_lshl_b32 s43, s42, 4
    s_add_i32 s43, s43, s26
    s_max_i32 s43, s43, 0
    s_mul_i32 s43, s43, 1152
    s_lshl_b32 s44, s41, 6
    s_add_u32 s43, s43, s44
    s_mul_i32 s42, s42, 18
    s_add_u32 s42, s42, s41
    s_lshl_b32 s42, s42, 10
    s_mov_b32 m0, s42
    s_add_u32 s40, s40, 8
    buffer_load_dwordx4 v5, s[16:19], s43 offen lds
    s_mul_i32 s41, s40, 205
    s_lshr_b32 s41, s41, 10
    s_mul_i32 s42, s41, 5
    s_sub_u32 s42, s40, s42
    s_lshl_b32 s43, s42, 4
    s_add_i32 s43, s43, s26
    s_max_i32 s43, s43, 0
    s_mul_i32 s43, s43, 1152
    s_lshl_b32 s44, s41, 6
    s_add_u32 s43, s43, s44
    s_mul_i32 s42, s42, 18
    s_add_u32 s42, s42, s41
    s_lshl_b32 s42, s42, 10
    s_mov_b32 m0, s42
    s_add_u32 s40, s40, 8
    buffer_load_dwordx4 v5, s[16:19], s43 offen lds
    s_mul_i32 s41, s40, 205
    s_lshr_b32 s41, s41, 10
    s_mul_i32 s42, s41, 5
    s_sub_u32 s42, s40, s42
    s_lshl_b32 s43, s42, 4
    s_add_i32 s43, s43, s26
    s_max_i32 s43, s43, 0
    s_mul_i32 s43, s43, 1152
    s_lshl_b32 s44, s41, 6
    s_add_u32 s43, s43, s44
    s_mul_i32 s42, s42, 18
    s_add_u32 s42, s42, s41
    s_lshl_b32 s42, s42, 10
    s_mov_b32 m0, s42
    s_add_u32 s40, s40, 8
    buffer_load_dwordx4 v5, s[16:19], s43 offen lds
    s_mul_i32 s41, s40, 205
    s_lshr_b32 s41, s41, 10
    s_mul_i32 s42, s41, 5
    s_sub_u32 s42, s40, s42
    s_lshl_b32 s43, s42, 4
    s_add_i32 s43, s43, s26
    s_max_i32 s43, s43, 0
    s_mul_i32 s43, s43, 1152
    s_lshl_b32 s44, s41, 6
    s_add_u32 s43, s43, s44
    s_mul_i32 s42, s42, 18
    s_add_u32 s42, s42, s41
    s_lshl_b32 s42, s42, 10
    s_mov_b32 m0, s42
    s_add_u32 s40, s40, 8
    buffer_load_dwordx4 v5, s[16:19], s43 offen lds
    s_mul_i32 s24, s13, 15
    s_lshl_b32 s25, s14, 1
    s_add_u32 s27, s24, s25
    s_mul_i32 s24, s27, 18432
    s_add_u32 s24, s24, 2359296
    s_add_u32 s25, s24, 18432
    buffer_load_dwordx4 v[96:99], v6, s[20:23], s24 offen offset:0
    buffer_load_dwordx4 v[168:171], v6, s[20:23], s25 offen offset:0
    buffer_load_dwordx4 v[100:103], v6, s[20:23], s24 offen offset:1024
    buffer_load_dwordx4 v[172:175], v6, s[20:23], s25 offen offset:1024
    buffer_load_dwordx4 v[104:107], v6, s[20:23], s24 offen offset:2048
    buffer_load_dwordx4 v[176:179], v6, s[20:23], s25 offen offset:2048
    buffer_load_dwordx4 v[108:111], v6, s[20:23], s24 offen offset:3072
    buffer_load_dwordx4 v[180:183], v6, s[20:23], s25 offen offset:3072
    s_mul_i32 s41, s40, 205
    s_lshr_b32 s41, s41, 10
    s_mul_i32 s42, s41, 5
    s_sub_u32 s42, s40, s42
    s_lshl_b32 s43, s42, 4
    s_add_i32 s43, s43, s26
    s_max_i32 s43, s43, 0
    s_mul_i32 s43, s43, 1152
    s_lshl_b32 s44, s41, 6
    s_add_u32 s43, s43, s44
    s_mul_i32 s42, s42, 18
    s_add_u32 s42, s42, s41
    s_lshl_b32 s42, s42, 10
    s_mov_b32 m0, s42
    s_add_u32 s40, s40, 8
    buffer_load_dwordx4 v5, s[16:19], s43 offen lds
    s_mul_i32 s41, s40, 205
    s_lshr_b32 s41, s41, 10
    s_mul_i32 s42, s41, 5
    s_sub_u32 s42, s40, s42
    s_lshl_b32 s43, s42, 4
    s_add_i32 s43, s43, s26
    s_max_i32 s43, s43, 0
    s_mul_i32 s43, s43, 1152
    s_lshl_b32 s44, s41, 6
    s_add_u32 s43, s43, s44
    s_mul_i32 s42, s42, 18
    s_add_u32 s42, s42, s41
    s_lshl_b32 s42, s42, 10
    s_mov_b32 m0, s42
    s_add_u32 s40, s40, 8
    buffer_load_dwordx4 v5, s[16:19], s43 offen lds
    s_mul_i32 s41, s40, 205
    s_lshr_b32 s41, s41, 10
    s_mul_i32 s42, s41, 5
    s_sub_u32 s42, s40, s42
    s_lshl_b32 s43, s42, 4
    s_add_i32 s43, s43, s26
    s_max_i32 s43, s43, 0
    s_mul_i32 s43, s43, 1152
    s_lshl_b32 s44, s41, 6
    s_add_u32 s43, s43, s44
    s_mul_i32 s42, s42, 18
    s_add_u32 s42, s42, s41
    s_lshl_b32 s42, s42, 10
    s_mov_b32 m0, s42
    s_add_u32 s40, s40, 8
    buffer_load_dwordx4 v5, s[16:19], s43 offen lds
    s_mul_i32 s41, s40, 205
    s_lshr_b32 s41, s41, 10
    s_mul_i32 s42, s41, 5
    s_sub_u32 s42, s40, s42
    s_lshl_b32 s43, s42, 4
    s_add_i32 s43, s43, s26
    s_max_i32 s43, s43, 0
    s_mul_i32 s43, s43, 1152
    s_lshl_b32 s44, s41, 6
    s_add_u32 s43, s43, s44
    s_mul_i32 s42, s42, 18
    s_add_u32 s42, s42, s41
    s_lshl_b32 s42, s42, 10
    s_mov_b32 m0, s42
    s_add_u32 s40, s40, 8
    buffer_load_dwordx4 v5, s[16:19], s43 offen lds
    s_lshl_b32 s27, s27, 6
    s_add_u32 s27, s27, 4657152
    v_lshlrev_b32 v12, 4, v8
    buffer_load_dwordx4 v[240:243], v12, s[20:23], s27 offen
    buffer_load_dwordx4 v[244:247], v12, s[20:23], s27 offen offset:64
    s_add_u32 s28, s27, 16384
    s_add_u32 s29, s27, 32768
    s_waitcnt vmcnt(14)
    s_cmp_ge_u32 s14, 2
    s_cbranch_scc1 qkvb0_nost2
    v_add_f32 v56, v56, v58
    v_add_f32 v57, v57, v59
    v_add_f32 v60, v60, v62
    v_add_f32 v61, v61, v63
    v_add_f32 v56, v56, v60
    v_add_f32 v57, v57, v61
    v_mul_f32 v56, 0x3ae38e39, v56
    v_mul_f32 v57, 0x3ae38e39, v57
    v_fma_f32 v57, -v56, v56, v57
    v_max_f32 v57, 0, v57
    v_cvt_pk_bf16_f32 v248, v56, v57
    v_and_b32 v58, 0xffff0000, v248
    v_lshlrev_b32 v57, 16, v248
    v_add_f32 v58, 0x3727c5ac, v58
    v_cvt_pk_bf16_f32 v248, v58, v58
    v_lshlrev_b32 v58, 16, v248
    v_sqrt_f32 v58, v58
    s_nop 0
    v_cvt_pk_bf16_f32 v248, v58, v58
    v_lshlrev_b32 v58, 16, v248
    v_rcp_f32 v56, v58
    s_nop 0
    v_lshlrev_b32 v11, 3, v0
    v_add_u32 v11, 92160, v11
    ds_write_b64 v11, v[56:57]
    s_waitcnt lgkmcnt(0)
qkvb0_nost2:
    s_barrier
    v_mov_b32 v56, 0
    v_mov_b32 v57, 0
    v_mov_b32 v58, 0
    v_mov_b32 v59, 0
    v_mov_b32 v60, 0
    v_mov_b32 v61, 0
    v_mov_b32 v62, 0
    v_mov_b32 v63, 0
    v_mov_b32 v64, 0
    v_mov_b32 v65, 0
    v_mov_b32 v66, 0
    v_mov_b32 v67, 0
    v_mov_b32 v68, 0
    v_mov_b32 v69, 0
    v_mov_b32 v70, 0
    v_mov_b32 v71, 0
    v_mov_b32 v72, 0
    v_mov_b32 v73, 0
    v_mov_b32 v74, 0
    v_mov_b32 v75, 0
    v_mov_b32 v76, 0
    v_mov_b32 v77, 0
    v_mov_b32 v78, 0
    v_mov_b32 v79, 0
    v_mov_b32 v80, 0
    v_mov_b32 v81, 0
    v_mov_b32 v82, 0
    v_mov_b32 v83, 0
    v_mov_b32 v84, 0
    v_mov_b32 v85, 0
    v_mov_b32 v86, 0
    v_mov_b32 v87, 0
    v_mov_b32 v88, 0
    v_mov_b32 v89, 0
    v_mov_b32 v90, 0
    v_mov_b32 v91, 0
    v_mov_b32 v92, 0
    v_mov_b32 v93, 0
    v_mov_b32 v94, 0
    v_mov_b32 v95, 0
    v_add_u32 v15, 55296, v6
    ds_read_b128 v[16:19], v6 offset:0
    ds_read_b128 v[20:23], v6 offset:18432
    ds_read_b128 v[24:27], v6 offset:36864
    ds_read_b128 v[28:31], v15 offset:0
    ds_read_b128 v[32:35], v15 offset:18432
    ds_read_b128 v[36:39], v6 offset:1024
    ds_read_b128 v[40:43], v6 offset:19456
    ds_read_b128 v[44:47], v6 offset:37888
    ds_read_b128 v[48:51], v15 offset:1024
    ds_read_b128 v[52:55], v15 offset:19456
    s_add_u32 s24, s24, 4096
    buffer_load_dwordx4 v[112:115], v6, s[20:23], s24 offen offset:0
    s_add_u32 s25, s25, 4096
    buffer_load_dwordx4 v[184:187], v6, s[20:23], s25 offen offset:0
    s_waitcnt vmcnt(14) lgkmcnt(5)
    v_mfma_f32_16x16x32_bf16 v[56:59], v[96:99], v[16:19], v[56:59]
    v_mfma_f32_16x16x32_bf16 v[60:63], v[168:171], v[16:19], v[60:63]
    v_mfma_f32_16x16x32_bf16 v[64:67], v[96:99], v[20:23], v[64:67]
    v_mfma_f32_16x16x32_bf16 v[68:71], v[168:171], v[20:23], v[68:71]
    v_mfma_f32_16x16x32_bf16 v[72:75], v[96:99], v[24:27], v[72:75]
    v_mfma_f32_16x16x32_bf16 v[76:79], v[168:171], v[24:27], v[76:79]
    v_mfma_f32_16x16x32_bf16 v[80:83], v[96:99], v[28:31], v[80:83]
    v_mfma_f32_16x16x32_bf16 v[84:87], v[168:171], v[28:31], v[84:87]
    v_mfma_f32_16x16x32_bf16 v[88:91], v[96:99], v[32:35], v[88:91]
    v_mfma_f32_16x16x32_bf16 v[92:95], v[168:171], v[32:35], v[92:95]
    ds_read_b128 v[16:19], v6 offset:2048
    ds_read_b128 v[20:23], v6 offset:20480
    ds_read_b128 v[24:27], v6 offset:38912
    ds_read_b128 v[28:31], v15 offset:2048
    ds_read_b128 v[32:35], v15 offset:20480
    s_mul_i32 s41, s40, 205
    s_lshr_b32 s41, s41, 10
    s_mul_i32 s42, s41, 5
    s_sub_u32 s42, s40, s42
    s_lshl_b32 s43, s42, 4
    s_add_i32 s43, s43, s26
    s_max_i32 s43, s43, 0
    s_mul_i32 s43, s43, 1152
    s_lshl_b32 s44, s41, 6
    s_add_u32 s43, s43, s44
    s_mul_i32 s42, s42, 18
    s_add_u32 s42, s42, s41
    s_lshl_b32 s42, s42, 10
    s_mov_b32 m0, s42
    s_add_u32 s40, s40, 8
    buffer_load_dwordx4 v5, s[16:19], s43 offen lds
    s_mul_i32 s41, s40, 205
    s_lshr_b32 s41, s41, 10
    s_mul_i32 s42, s41, 5
    s_sub_u32 s42, s40, s42
    s_lshl_b32 s43, s42, 4
    s_add_i32 s43, s43, s26
    s_max_i32 s43, s43, 0
    s_mul_i32 s43, s43, 1152
    s_lshl_b32 s44, s41, 6
    s_add_u32 s43, s43, s44
    s_mul_i32 s42, s42, 18
    s_add_u32 s42, s42, s41
    s_lshl_b32 s42, s42, 10
    s_mov_b32 m0, s42
    s_add_u32 s40, s40, 8
    buffer_load_dwordx4 v5, s[16:19], s43 offen lds
    s_mul_i32 s41, s40, 205
    s_lshr_b32 s41, s41, 10
    s_mul_i32 s42, s41, 5
    s_sub_u32 s42, s40, s42
    s_lshl_b32 s43, s42, 4
    s_add_i32 s43, s43, s26
    s_max_i32 s43, s43, 0
    s_mul_i32 s43, s43, 1152
    s_lshl_b32 s44, s41, 6
    s_add_u32 s43, s43, s44
    s_mul_i32 s42, s42, 18
    s_add_u32 s42, s42, s41
    s_lshl_b32 s42, s42, 10
    s_mov_b32 m0, s42
    s_add_u32 s40, s40, 8
    buffer_load_dwordx4 v5, s[16:19], s43 offen lds
    s_cmp_ge_u32 s40, 90
    s_cbranch_scc1 qkvb0_dmadone
    s_mul_i32 s41, s40, 205
    s_lshr_b32 s41, s41, 10
    s_mul_i32 s42, s41, 5
    s_sub_u32 s42, s40, s42
    s_lshl_b32 s43, s42, 4
    s_add_i32 s43, s43, s26
    s_max_i32 s43, s43, 0
    s_mul_i32 s43, s43, 1152
    s_lshl_b32 s44, s41, 6
    s_add_u32 s43, s43, s44
    s_mul_i32 s42, s42, 18
    s_add_u32 s42, s42, s41
    s_lshl_b32 s42, s42, 10
    s_mov_b32 m0, s42
    s_add_u32 s40, s40, 8
    buffer_load_dwordx4 v5, s[16:19], s43 offen lds
qkvb0_dmadone:
    buffer_load_dwordx4 v[116:119], v6, s[20:23], s24 offen offset:1024
    buffer_load_dwordx4 v[188:191], v6, s[20:23], s25 offen offset:1024
    s_waitcnt vmcnt(17) lgkmcnt(5)
    v_mfma_f32_16x16x32_bf16 v[56:59], v[100:103], v[36:39], v[56:59]
    v_mfma_f32_16x16x32_bf16 v[60:63], v[172:175], v[36:39], v[60:63]
    v_mfma_f32_16x16x32_bf16 v[64:67], v[100:103], v[40:43], v[64:67]
    v_mfma_f32_16x16x32_bf16 v[68:71], v[172:175], v[40:43], v[68:71]
    v_mfma_f32_16x16x32_bf16 v[72:75], v[100:103], v[44:47], v[72:75]
    v_mfma_f32_16x16x32_bf16 v[76:79], v[172:175], v[44:47], v[76:79]
    v_mfma_f32_16x16x32_bf16 v[80:83], v[100:103], v[48:51], v[80:83]
    v_mfma_f32_16x16x32_bf16 v[84:87], v[172:175], v[48:51], v[84:87]
    v_mfma_f32_16x16x32_bf16 v[88:91], v[100:103], v[52:55], v[88:91]
    v_mfma_f32_16x16x32_bf16 v[92:95], v[172:175], v[52:55], v[92:95]
    ds_read_b128 v[36:39], v6 offset:3072
    ds_read_b128 v[40:43], v6 offset:21504
    ds_read_b128 v[44:47], v6 offset:39936
    ds_read_b128 v[48:51], v15 offset:3072
    ds_read_b128 v[52:55], v15 offset:21504
    buffer_load_dwordx4 v[120:123], v6, s[20:23], s24 offen offset:2048
    buffer_load_dwordx4 v[192:195], v6, s[20:23], s25 offen offset:2048
    s_waitcnt vmcnt(17) lgkmcnt(5)
    v_mfma_f32_16x16x32_bf16 v[56:59], v[104:107], v[16:19], v[56:59]
    v_mfma_f32_16x16x32_bf16 v[60:63], v[176:179], v[16:19], v[60:63]
    v_mfma_f32_16x16x32_bf16 v[64:67], v[104:107], v[20:23], v[64:67]
    v_mfma_f32_16x16x32_bf16 v[68:71], v[176:179], v[20:23], v[68:71]
    v_mfma_f32_16x16x32_bf16 v[72:75], v[104:107], v[24:27], v[72:75]
    v_mfma_f32_16x16x32_bf16 v[76:79], v[176:179], v[24:27], v[76:79]
    v_mfma_f32_16x16x32_bf16 v[80:83], v[104:107], v[28:31], v[80:83]
    v_mfma_f32_16x16x32_bf16 v[84:87], v[176:179], v[28:31], v[84:87]
    v_mfma_f32_16x16x32_bf16 v[88:91], v[104:107], v[32:35], v[88:91]
    v_mfma_f32_16x16x32_bf16 v[92:95], v[176:179], v[32:35], v[92:95]
    ds_read_b128 v[16:19], v6 offset:4096
    ds_read_b128 v[20:23], v6 offset:22528
    ds_read_b128 v[24:27], v6 offset:40960
    ds_read_b128 v[28:31], v15 offset:4096
    ds_read_b128 v[32:35], v15 offset:22528
    buffer_load_dwordx4 v[248:251], v12, s[20:23], s28 offen
    buffer_load_dwordx4 v[252:255], v12, s[20:23], s28 offen offset:64
    buffer_load_dwordx4 v[124:127], v6, s[20:23], s24 offen offset:3072
    buffer_load_dwordx4 v[196:199], v6, s[20:23], s25 offen offset:3072
    s_waitcnt vmcnt(19) lgkmcnt(5)
    v_mfma_f32_16x16x32_bf16 v[56:59], v[108:111], v[36:39], v[56:59]
    v_mfma_f32_16x16x32_bf16 v[60:63], v[180:183], v[36:39], v[60:63]
    v_mfma_f32_16x16x32_bf16 v[64:67], v[108:111], v[40:43], v[64:67]
    v_mfma_f32_16x16x32_bf16 v[68:71], v[180:183], v[40:43], v[68:71]
    v_mfma_f32_16x16x32_bf16 v[72:75], v[108:111], v[44:47], v[72:75]
    v_mfma_f32_16x16x32_bf16 v[76:79], v[180:183], v[44:47], v[76:79]
    v_mfma_f32_16x16x32_bf16 v[80:83], v[108:111], v[48:51], v[80:83]
    v_mfma_f32_16x16x32_bf16 v[84:87], v[180:183], v[48:51], v[84:87]
    v_mfma_f32_16x16x32_bf16 v[88:91], v[108:111], v[52:55], v[88:91]
    v_mfma_f32_16x16x32_bf16 v[92:95], v[180:183], v[52:55], v[92:95]
    ds_read_b128 v[36:39], v6 offset:5120
    ds_read_b128 v[40:43], v6 offset:23552
    ds_read_b128 v[44:47], v6 offset:41984
    ds_read_b128 v[48:51], v15 offset:5120
    ds_read_b128 v[52:55], v15 offset:23552
    s_add_u32 s24, s24, 4096
    buffer_load_dwordx4 v[128:131], v6, s[20:23], s24 offen offset:0
    s_add_u32 s25, s25, 4096
    buffer_load_dwordx4 v[200:203], v6, s[20:23], s25 offen offset:0
    s_waitcnt vmcnt(13) lgkmcnt(5)
    v_mfma_f32_16x16x32_bf16 v[56:59], v[112:115], v[16:19], v[56:59]
    v_mfma_f32_16x16x32_bf16 v[60:63], v[184:187], v[16:19], v[60:63]
    v_mfma_f32_16x16x32_bf16 v[64:67], v[112:115], v[20:23], v[64:67]
    v_mfma_f32_16x16x32_bf16 v[68:71], v[184:187], v[20:23], v[68:71]
    v_mfma_f32_16x16x32_bf16 v[72:75], v[112:115], v[24:27], v[72:75]
    v_mfma_f32_16x16x32_bf16 v[76:79], v[184:187], v[24:27], v[76:79]
    v_mfma_f32_16x16x32_bf16 v[80:83], v[112:115], v[28:31], v[80:83]
    v_mfma_f32_16x16x32_bf16 v[84:87], v[184:187], v[28:31], v[84:87]
    v_mfma_f32_16x16x32_bf16 v[88:91], v[112:115], v[32:35], v[88:91]
    v_mfma_f32_16x16x32_bf16 v[92:95], v[184:187], v[32:35], v[92:95]
    s_waitcnt vmcnt(17)
    s_barrier
    ds_read_b128 v[16:19], v6 offset:6144
    ds_read_b128 v[20:23], v6 offset:24576
    ds_read_b128 v[24:27], v6 offset:43008
    ds_read_b128 v[28:31], v15 offset:6144
    ds_read_b128 v[32:35], v15 offset:24576
    buffer_load_dwordx4 v[132:135], v6, s[20:23], s24 offen offset:1024
    buffer_load_dwordx4 v[204:207], v6, s[20:23], s25 offen offset:1024
    s_waitcnt vmcnt(10) lgkmcnt(5)
    v_mfma_f32_16x16x32_bf16 v[56:59], v[116:119], v[36:39], v[56:59]
    v_mfma_f32_16x16x32_bf16 v[60:63], v[188:191], v[36:39], v[60:63]
    v_mfma_f32_16x16x32_bf16 v[64:67], v[116:119], v[40:43], v[64:67]
    v_mfma_f32_16x16x32_bf16 v[68:71], v[188:191], v[40:43], v[68:71]
    v_mfma_f32_16x16x32_bf16 v[72:75], v[116:119], v[44:47], v[72:75]
    v_mfma_f32_16x16x32_bf16 v[76:79], v[188:191], v[44:47], v[76:79]
    v_mfma_f32_16x16x32_bf16 v[80:83], v[116:119], v[48:51], v[80:83]
    v_mfma_f32_16x16x32_bf16 v[84:87], v[188:191], v[48:51], v[84:87]
    v_mfma_f32_16x16x32_bf16 v[88:91], v[116:119], v[52:55], v[88:91]
    v_mfma_f32_16x16x32_bf16 v[92:95], v[188:191], v[52:55], v[92:95]
    ds_read_b128 v[36:39], v6 offset:7168
    ds_read_b128 v[40:43], v6 offset:25600
    ds_read_b128 v[44:47], v6 offset:44032
    ds_read_b128 v[48:51], v15 offset:7168
    ds_read_b128 v[52:55], v15 offset:25600
    buffer_load_dwordx4 v[136:139], v6, s[20:23], s24 offen offset:2048
    buffer_load_dwordx4 v[208:211], v6, s[20:23], s25 offen offset:2048
    s_waitcnt vmcnt(10) lgkmcnt(5)
    v_mfma_f32_16x16x32_bf16 v[56:59], v[120:123], v[16:19], v[56:59]
    v_mfma_f32_16x16x32_bf16 v[60:63], v[192:195], v[16:19], v[60:63]
    v_mfma_f32_16x16x32_bf16 v[64:67], v[120:123], v[20:23], v[64:67]
    v_mfma_f32_16x16x32_bf16 v[68:71], v[192:195], v[20:23], v[68:71]
    v_mfma_f32_16x16x32_bf16 v[72:75], v[120:123], v[24:27], v[72:75]
    v_mfma_f32_16x16x32_bf16 v[76:79], v[192:195], v[24:27], v[76:79]
    v_mfma_f32_16x16x32_bf16 v[80:83], v[120:123], v[28:31], v[80:83]
    v_mfma_f32_16x16x32_bf16 v[84:87], v[192:195], v[28:31], v[84:87]
    v_mfma_f32_16x16x32_bf16 v[88:91], v[120:123], v[32:35], v[88:91]
    v_mfma_f32_16x16x32_bf16 v[92:95], v[192:195], v[32:35], v[92:95]
    ds_read_b128 v[16:19], v6 offset:8192
    ds_read_b128 v[20:23], v6 offset:26624
    ds_read_b128 v[24:27], v6 offset:45056
    ds_read_b128 v[28:31], v15 offset:8192
    ds_read_b128 v[32:35], v15 offset:26624
    buffer_load_dwordx4 v[140:143], v6, s[20:23], s24 offen offset:3072
    buffer_load_dwordx4 v[212:215], v6, s[20:23], s25 offen offset:3072
    s_waitcnt vmcnt(8) lgkmcnt(5)
    v_mfma_f32_16x16x32_bf16 v[56:59], v[124:127], v[36:39], v[56:59]
    v_mfma_f32_16x16x32_bf16 v[60:63], v[196:199], v[36:39], v[60:63]
    v_mfma_f32_16x16x32_bf16 v[64:67], v[124:127], v[40:43], v[64:67]
    v_mfma_f32_16x16x32_bf16 v[68:71], v[196:199], v[40:43], v[68:71]
    v_mfma_f32_16x16x32_bf16 v[72:75], v[124:127], v[44:47], v[72:75]
    v_mfma_f32_16x16x32_bf16 v[76:79], v[196:199], v[44:47], v[76:79]
    v_mfma_f32_16x16x32_bf16 v[80:83], v[124:127], v[48:51], v[80:83]
    v_mfma_f32_16x16x32_bf16 v[84:87], v[196:199], v[48:51], v[84:87]
    v_mfma_f32_16x16x32_bf16 v[88:91], v[124:127], v[52:55], v[88:91]
    v_mfma_f32_16x16x32_bf16 v[92:95], v[196:199], v[52:55], v[92:95]
    ds_read_b128 v[36:39], v6 offset:9216
    ds_read_b128 v[40:43], v6 offset:27648
    ds_read_b128 v[44:47], v6 offset:46080
    ds_read_b128 v[48:51], v15 offset:9216
    ds_read_b128 v[52:55], v15 offset:27648
    s_add_u32 s24, s24, 4096
    buffer_load_dwordx4 v[144:147], v6, s[20:23], s24 offen offset:0
    s_add_u32 s25, s25, 4096
    buffer_load_dwordx4 v[216:219], v6, s[20:23], s25 offen offset:0
    s_waitcnt vmcnt(8) lgkmcnt(5)
    v_mfma_f32_16x16x32_bf16 v[56:59], v[128:131], v[16:19], v[56:59]
    v_mfma_f32_16x16x32_bf16 v[60:63], v[200:203], v[16:19], v[60:63]
    v_mfma_f32_16x16x32_bf16 v[64:67], v[128:131], v[20:23], v[64:67]
    v_mfma_f32_16x16x32_bf16 v[68:71], v[200:203], v[20:23], v[68:71]
    v_mfma_f32_16x16x32_bf16 v[72:75], v[128:131], v[24:27], v[72:75]
    v_mfma_f32_16x16x32_bf16 v[76:79], v[200:203], v[24:27], v[76:79]
    v_mfma_f32_16x16x32_bf16 v[80:83], v[128:131], v[28:31], v[80:83]
    v_mfma_f32_16x16x32_bf16 v[84:87], v[200:203], v[28:31], v[84:87]
    v_mfma_f32_16x16x32_bf16 v[88:91], v[128:131], v[32:35], v[88:91]
    v_mfma_f32_16x16x32_bf16 v[92:95], v[200:203], v[32:35], v[92:95]
    ds_read_b128 v[16:19], v6 offset:10240
    ds_read_b128 v[20:23], v6 offset:28672
    ds_read_b128 v[24:27], v6 offset:47104
    ds_read_b128 v[28:31], v15 offset:10240
    ds_read_b128 v[32:35], v15 offset:28672
    buffer_load_dwordx4 v[148:151], v6, s[20:23], s24 offen offset:1024
    buffer_load_dwordx4 v[220:223], v6, s[20:23], s25 offen offset:1024
    s_waitcnt vmcnt(8) lgkmcnt(5)
    v_mfma_f32_16x16x32_bf16 v[56:59], v[132:135], v[36:39], v[56:59]
    v_mfma_f32_16x16x32_bf16 v[60:63], v[204:207], v[36:39], v[60:63]
    v_mfma_f32_16x16x32_bf16 v[64:67], v[132:135], v[40:43], v[64:67]
    v_mfma_f32_16x16x32_bf16 v[68:71], v[204:207], v[40:43], v[68:71]
    v_mfma_f32_16x16x32_bf16 v[72:75], v[132:135], v[44:47], v[72:75]
    v_mfma_f32_16x16x32_bf16 v[76:79], v[204:207], v[44:47], v[76:79]
    v_mfma_f32_16x16x32_bf16 v[80:83], v[132:135], v[48:51], v[80:83]
    v_mfma_f32_16x16x32_bf16 v[84:87], v[204:207], v[48:51], v[84:87]
    v_mfma_f32_16x16x32_bf16 v[88:91], v[132:135], v[52:55], v[88:91]
    v_mfma_f32_16x16x32_bf16 v[92:95], v[204:207], v[52:55], v[92:95]
    ds_read_b128 v[36:39], v6 offset:11264
    ds_read_b128 v[40:43], v6 offset:29696
    ds_read_b128 v[44:47], v6 offset:48128
    ds_read_b128 v[48:51], v15 offset:11264
    ds_read_b128 v[52:55], v15 offset:29696
    s_waitcnt vmcnt(14)
    v_add_f32 v240, v240, v248
    v_add_f32 v241, v241, v249
    v_add_f32 v242, v242, v250
    v_add_f32 v243, v243, v251
    v_add_f32 v244, v244, v252
    v_add_f32 v245, v245, v253
    v_add_f32 v246, v246, v254
    v_add_f32 v247, v247, v255
    buffer_load_dwordx4 v[248:251], v12, s[20:23], s29 offen
    buffer_load_dwordx4 v[252:255], v12, s[20:23], s29 offen offset:64
    buffer_load_dwordx4 v[152:155], v6, s[20:23], s24 offen offset:2048
    buffer_load_dwordx4 v[224:227], v6, s[20:23], s25 offen offset:2048
    s_waitcnt vmcnt(10) lgkmcnt(5)
    v_mfma_f32_16x16x32_bf16 v[56:59], v[136:139], v[16:19], v[56:59]
    v_mfma_f32_16x16x32_bf16 v[60:63], v[208:211], v[16:19], v[60:63]
    v_mfma_f32_16x16x32_bf16 v[64:67], v[136:139], v[20:23], v[64:67]
    v_mfma_f32_16x16x32_bf16 v[68:71], v[208:211], v[20:23], v[68:71]
    v_mfma_f32_16x16x32_bf16 v[72:75], v[136:139], v[24:27], v[72:75]
    v_mfma_f32_16x16x32_bf16 v[76:79], v[208:211], v[24:27], v[76:79]
    v_mfma_f32_16x16x32_bf16 v[80:83], v[136:139], v[28:31], v[80:83]
    v_mfma_f32_16x16x32_bf16 v[84:87], v[208:211], v[28:31], v[84:87]
    v_mfma_f32_16x16x32_bf16 v[88:91], v[136:139], v[32:35], v[88:91]
    v_mfma_f32_16x16x32_bf16 v[92:95], v[208:211], v[32:35], v[92:95]
    s_waitcnt vmcnt(24)
    s_barrier
    ds_read_b128 v[16:19], v6 offset:12288
    ds_read_b128 v[20:23], v6 offset:30720
    ds_read_b128 v[24:27], v6 offset:49152
    ds_read_b128 v[28:31], v15 offset:12288
    ds_read_b128 v[32:35], v15 offset:30720
    buffer_load_dwordx4 v[156:159], v6, s[20:23], s24 offen offset:3072
    buffer_load_dwordx4 v[228:231], v6, s[20:23], s25 offen offset:3072
    s_waitcnt vmcnt(10) lgkmcnt(5)
    v_mfma_f32_16x16x32_bf16 v[56:59], v[140:143], v[36:39], v[56:59]
    v_mfma_f32_16x16x32_bf16 v[60:63], v[212:215], v[36:39], v[60:63]
    v_mfma_f32_16x16x32_bf16 v[64:67], v[140:143], v[40:43], v[64:67]
    v_mfma_f32_16x16x32_bf16 v[68:71], v[212:215], v[40:43], v[68:71]
    v_mfma_f32_16x16x32_bf16 v[72:75], v[140:143], v[44:47], v[72:75]
    v_mfma_f32_16x16x32_bf16 v[76:79], v[212:215], v[44:47], v[76:79]
    v_mfma_f32_16x16x32_bf16 v[80:83], v[140:143], v[48:51], v[80:83]
    v_mfma_f32_16x16x32_bf16 v[84:87], v[212:215], v[48:51], v[84:87]
    v_mfma_f32_16x16x32_bf16 v[88:91], v[140:143], v[52:55], v[88:91]
    v_mfma_f32_16x16x32_bf16 v[92:95], v[212:215], v[52:55], v[92:95]
    ds_read_b128 v[36:39], v6 offset:13312
    ds_read_b128 v[40:43], v6 offset:31744
    ds_read_b128 v[44:47], v6 offset:50176
    ds_read_b128 v[48:51], v15 offset:13312
    ds_read_b128 v[52:55], v15 offset:31744
    s_add_u32 s24, s24, 4096
    buffer_load_dwordx4 v[160:163], v6, s[20:23], s24 offen offset:0
    s_add_u32 s25, s25, 4096
    buffer_load_dwordx4 v[232:235], v6, s[20:23], s25 offen offset:0
    s_waitcnt vmcnt(10) lgkmcnt(5)
    v_mfma_f32_16x16x32_bf16 v[56:59], v[144:147], v[16:19], v[56:59]
    v_mfma_f32_16x16x32_bf16 v[60:63], v[216:219], v[16:19], v[60:63]
    v_mfma_f32_16x16x32_bf16 v[64:67], v[144:147], v[20:23], v[64:67]
    v_mfma_f32_16x16x32_bf16 v[68:71], v[216:219], v[20:23], v[68:71]
    v_mfma_f32_16x16x32_bf16 v[72:75], v[144:147], v[24:27], v[72:75]
    v_mfma_f32_16x16x32_bf16 v[76:79], v[216:219], v[24:27], v[76:79]
    v_mfma_f32_16x16x32_bf16 v[80:83], v[144:147], v[28:31], v[80:83]
    v_mfma_f32_16x16x32_bf16 v[84:87], v[216:219], v[28:31], v[84:87]
    v_mfma_f32_16x16x32_bf16 v[88:91], v[144:147], v[32:35], v[88:91]
    v_mfma_f32_16x16x32_bf16 v[92:95], v[216:219], v[32:35], v[92:95]
    ds_read_b128 v[16:19], v6 offset:14336
    ds_read_b128 v[20:23], v6 offset:32768
    ds_read_b128 v[24:27], v6 offset:51200
    ds_read_b128 v[28:31], v15 offset:14336
    ds_read_b128 v[32:35], v15 offset:32768
    buffer_load_dwordx4 v[164:167], v6, s[20:23], s24 offen offset:1024
    buffer_load_dwordx4 v[236:239], v6, s[20:23], s25 offen offset:1024
    s_waitcnt vmcnt(10) lgkmcnt(5)
    v_mfma_f32_16x16x32_bf16 v[56:59], v[148:151], v[36:39], v[56:59]
    v_mfma_f32_16x16x32_bf16 v[60:63], v[220:223], v[36:39], v[60:63]
    v_mfma_f32_16x16x32_bf16 v[64:67], v[148:151], v[40:43], v[64:67]
    v_mfma_f32_16x16x32_bf16 v[68:71], v[220:223], v[40:43], v[68:71]
    v_mfma_f32_16x16x32_bf16 v[72:75], v[148:151], v[44:47], v[72:75]
    v_mfma_f32_16x16x32_bf16 v[76:79], v[220:223], v[44:47], v[76:79]
    v_mfma_f32_16x16x32_bf16 v[80:83], v[148:151], v[48:51], v[80:83]
    v_mfma_f32_16x16x32_bf16 v[84:87], v[220:223], v[48:51], v[84:87]
    v_mfma_f32_16x16x32_bf16 v[88:91], v[148:151], v[52:55], v[88:91]
    v_mfma_f32_16x16x32_bf16 v[92:95], v[220:223], v[52:55], v[92:95]
    ds_read_b128 v[36:39], v6 offset:15360
    ds_read_b128 v[40:43], v6 offset:33792
    ds_read_b128 v[44:47], v6 offset:52224
    ds_read_b128 v[48:51], v15 offset:15360
    ds_read_b128 v[52:55], v15 offset:33792
    s_waitcnt vmcnt(6) lgkmcnt(5)
    v_mfma_f32_16x16x32_bf16 v[56:59], v[152:155], v[16:19], v[56:59]
    v_mfma_f32_16x16x32_bf16 v[60:63], v[224:227], v[16:19], v[60:63]
    v_mfma_f32_16x16x32_bf16 v[64:67], v[152:155], v[20:23], v[64:67]
    v_mfma_f32_16x16x32_bf16 v[68:71], v[224:227], v[20:23], v[68:71]
    v_mfma_f32_16x16x32_bf16 v[72:75], v[152:155], v[24:27], v[72:75]
    v_mfma_f32_16x16x32_bf16 v[76:79], v[224:227], v[24:27], v[76:79]
    v_mfma_f32_16x16x32_bf16 v[80:83], v[152:155], v[28:31], v[80:83]
    v_mfma_f32_16x16x32_bf16 v[84:87], v[224:227], v[28:31], v[84:87]
    v_mfma_f32_16x16x32_bf16 v[88:91], v[152:155], v[32:35], v[88:91]
    v_mfma_f32_16x16x32_bf16 v[92:95], v[224:227], v[32:35], v[92:95]
    ds_read_b128 v[16:19], v6 offset:16384
    ds_read_b128 v[20:23], v6 offset:34816
    ds_read_b128 v[24:27], v6 offset:53248
    ds_read_b128 v[28:31], v15 offset:16384
    ds_read_b128 v[32:35], v15 offset:34816
    s_waitcnt vmcnt(4) lgkmcnt(5)
    v_mfma_f32_16x16x32_bf16 v[56:59], v[156:159], v[36:39], v[56:59]
    v_mfma_f32_16x16x32_bf16 v[60:63], v[228:231], v[36:39], v[60:63]
    v_mfma_f32_16x16x32_bf16 v[64:67], v[156:159], v[40:43], v[64:67]
    v_mfma_f32_16x16x32_bf16 v[68:71], v[228:231], v[40:43], v[68:71]
    v_mfma_f32_16x16x32_bf16 v[72:75], v[156:159], v[44:47], v[72:75]
    v_mfma_f32_16x16x32_bf16 v[76:79], v[228:231], v[44:47], v[76:79]
    v_mfma_f32_16x16x32_bf16 v[80:83], v[156:159], v[48:51], v[80:83]
    v_mfma_f32_16x16x32_bf16 v[84:87], v[228:231], v[48:51], v[84:87]
    v_mfma_f32_16x16x32_bf16 v[88:91], v[156:159], v[52:55], v[88:91]
    v_mfma_f32_16x16x32_bf16 v[92:95], v[228:231], v[52:55], v[92:95]
    ds_read_b128 v[36:39], v6 offset:17408
    ds_read_b128 v[40:43], v6 offset:35840
    ds_read_b128 v[44:47], v6 offset:54272
    ds_read_b128 v[48:51], v15 offset:17408
    ds_read_b128 v[52:55], v15 offset:35840
    s_waitcnt vmcnt(2) lgkmcnt(5)
    v_mfma_f32_16x16x32_bf16 v[56:59], v[160:163], v[16:19], v[56:59]
    v_mfma_f32_16x16x32_bf16 v[60:63], v[232:235], v[16:19], v[60:63]
    v_mfma_f32_16x16x32_bf16 v[64:67], v[160:163], v[20:23], v[64:67]
    v_mfma_f32_16x16x32_bf16 v[68:71], v[232:235], v[20:23], v[68:71]
    v_mfma_f32_16x16x32_bf16 v[72:75], v[160:163], v[24:27], v[72:75]
    v_mfma_f32_16x16x32_bf16 v[76:79], v[232:235], v[24:27], v[76:79]
    v_mfma_f32_16x16x32_bf16 v[80:83], v[160:163], v[28:31], v[80:83]
    v_mfma_f32_16x16x32_bf16 v[84:87], v[232:235], v[28:31], v[84:87]
    v_mfma_f32_16x16x32_bf16 v[88:91], v[160:163], v[32:35], v[88:91]
    v_mfma_f32_16x16x32_bf16 v[92:95], v[232:235], v[32:35], v[92:95]
    s_waitcnt vmcnt(0) lgkmcnt(0)
    v_mfma_f32_16x16x32_bf16 v[56:59], v[164:167], v[36:39], v[56:59]
    v_mfma_f32_16x16x32_bf16 v[60:63], v[236:239], v[36:39], v[60:63]
    v_mfma_f32_16x16x32_bf16 v[64:67], v[164:167], v[40:43], v[64:67]
    v_mfma_f32_16x16x32_bf16 v[68:71], v[236:239], v[40:43], v[68:71]
    v_mfma_f32_16x16x32_bf16 v[72:75], v[164:167], v[44:47], v[72:75]
    v_mfma_f32_16x16x32_bf16 v[76:79], v[236:239], v[44:47], v[76:79]
    v_mfma_f32_16x16x32_bf16 v[80:83], v[164:167], v[48:51], v[80:83]
    v_mfma_f32_16x16x32_bf16 v[84:87], v[236:239], v[48:51], v[84:87]
    v_mfma_f32_16x16x32_bf16 v[88:91], v[164:167], v[52:55], v[88:91]
    v_mfma_f32_16x16x32_bf16 v[92:95], v[236:239], v[52:55], v[92:95]
    v_lshlrev_b32 v11, 3, v7
    v_add_u32 v11, 92160, v11
    ds_read_b64 v[16:17], v11 offset:0
    ds_read_b64 v[18:19], v11 offset:128
    ds_read_b64 v[20:21], v11 offset:256
    ds_read_b64 v[22:23], v11 offset:384
    ds_read_b64 v[24:25], v11 offset:512
    s_waitcnt vmcnt(0) lgkmcnt(0)
    s_nop 3
    s_barrier
    v_add_f32 v240, v240, v248
    v_add_f32 v241, v241, v249
    v_add_f32 v242, v242, v250
    v_add_f32 v243, v243, v251
    v_add_f32 v244, v244, v252
    v_add_f32 v245, v245, v253
    v_add_f32 v246, v246, v254
    v_add_f32 v247, v247, v255
    v_mul_u32_u24 v9, 480, v7
    v_lshl_add_u32 v9, v8, 3, v9
    s_lshl_b32 s24, s14, 6
    v_add_u32 v9, s24, v9
    v_fma_f32 v56, -v17, v240, v56
    v_mul_f32 v56, v16, v56
    v_fma_f32 v57, -v17, v241, v57
    v_mul_f32 v57, v16, v57
    v_fma_f32 v58, -v17, v242, v58
    v_mul_f32 v58, v16, v58
    v_fma_f32 v59, -v17, v243, v59
    v_mul_f32 v59, v16, v59
    v_cvt_pk_bf16_f32 v248, v56, v57
    v_cvt_pk_bf16_f32 v249, v58, v59
    ds_write_b64 v9, v[248:249] offset:0
    s_cmp_eq_u32 s14, 7
    s_cbranch_scc1 qkvb0_skipw0
    v_fma_f32 v60, -v17, v244, v60
    v_mul_f32 v60, v16, v60
    v_fma_f32 v61, -v17, v245, v61
    v_mul_f32 v61, v16, v61
    v_fma_f32 v62, -v17, v246, v62
    v_mul_f32 v62, v16, v62
    v_fma_f32 v63, -v17, v247, v63
    v_mul_f32 v63, v16, v63
    v_cvt_pk_bf16_f32 v248, v60, v61
    v_cvt_pk_bf16_f32 v249, v62, v63
    ds_write_b64 v9, v[248:249] offset:32
qkvb0_skipw0:
    v_fma_f32 v64, -v19, v240, v64
    v_mul_f32 v64, v18, v64
    v_fma_f32 v65, -v19, v241, v65
    v_mul_f32 v65, v18, v65
    v_fma_f32 v66, -v19, v242, v66
    v_mul_f32 v66, v18, v66
    v_fma_f32 v67, -v19, v243, v67
    v_mul_f32 v67, v18, v67
    v_cvt_pk_bf16_f32 v248, v64, v65
    v_cvt_pk_bf16_f32 v249, v66, v67
    ds_write_b64 v9, v[248:249] offset:7680
    s_cmp_eq_u32 s14, 7
    s_cbranch_scc1 qkvb0_skipw1
    v_fma_f32 v68, -v19, v244, v68
    v_mul_f32 v68, v18, v68
    v_fma_f32 v69, -v19, v245, v69
    v_mul_f32 v69, v18, v69
    v_fma_f32 v70, -v19, v246, v70
    v_mul_f32 v70, v18, v70
    v_fma_f32 v71, -v19, v247, v71
    v_mul_f32 v71, v18, v71
    v_cvt_pk_bf16_f32 v248, v68, v69
    v_cvt_pk_bf16_f32 v249, v70, v71
    ds_write_b64 v9, v[248:249] offset:7712
qkvb0_skipw1:
    v_fma_f32 v72, -v21, v240, v72
    v_mul_f32 v72, v20, v72
    v_fma_f32 v73, -v21, v241, v73
    v_mul_f32 v73, v20, v73
    v_fma_f32 v74, -v21, v242, v74
    v_mul_f32 v74, v20, v74
    v_fma_f32 v75, -v21, v243, v75
    v_mul_f32 v75, v20, v75
    v_cvt_pk_bf16_f32 v248, v72, v73
    v_cvt_pk_bf16_f32 v249, v74, v75
    ds_write_b64 v9, v[248:249] offset:15360
    s_cmp_eq_u32 s14, 7
    s_cbranch_scc1 qkvb0_skipw2
    v_fma_f32 v76, -v21, v244, v76
    v_mul_f32 v76, v20, v76
    v_fma_f32 v77, -v21, v245, v77
    v_mul_f32 v77, v20, v77
    v_fma_f32 v78, -v21, v246, v78
    v_mul_f32 v78, v20, v78
    v_fma_f32 v79, -v21, v247, v79
    v_mul_f32 v79, v20, v79
    v_cvt_pk_bf16_f32 v248, v76, v77
    v_cvt_pk_bf16_f32 v249, v78, v79
    ds_write_b64 v9, v[248:249] offset:15392
qkvb0_skipw2:
    v_fma_f32 v80, -v23, v240, v80
    v_mul_f32 v80, v22, v80
    v_fma_f32 v81, -v23, v241, v81
    v_mul_f32 v81, v22, v81
    v_fma_f32 v82, -v23, v242, v82
    v_mul_f32 v82, v22, v82
    v_fma_f32 v83, -v23, v243, v83
    v_mul_f32 v83, v22, v83
    v_cvt_pk_bf16_f32 v248, v80, v81
    v_cvt_pk_bf16_f32 v249, v82, v83
    ds_write_b64 v9, v[248:249] offset:23040
    s_cmp_eq_u32 s14, 7
    s_cbranch_scc1 qkvb0_skipw3
    v_fma_f32 v84, -v23, v244, v84
    v_mul_f32 v84, v22, v84
    v_fma_f32 v85, -v23, v245, v85
    v_mul_f32 v85, v22, v85
    v_fma_f32 v86, -v23, v246, v86
    v_mul_f32 v86, v22, v86
    v_fma_f32 v87, -v23, v247, v87
    v_mul_f32 v87, v22, v87
    v_cvt_pk_bf16_f32 v248, v84, v85
    v_cvt_pk_bf16_f32 v249, v86, v87
    ds_write_b64 v9, v[248:249] offset:23072
qkvb0_skipw3:
    v_fma_f32 v88, -v25, v240, v88
    v_mul_f32 v88, v24, v88
    v_fma_f32 v89, -v25, v241, v89
    v_mul_f32 v89, v24, v89
    v_fma_f32 v90, -v25, v242, v90
    v_mul_f32 v90, v24, v90
    v_fma_f32 v91, -v25, v243, v91
    v_mul_f32 v91, v24, v91
    v_cvt_pk_bf16_f32 v248, v88, v89
    v_cvt_pk_bf16_f32 v249, v90, v91
    ds_write_b64 v9, v[248:249] offset:30720
    s_cmp_eq_u32 s14, 7
    s_cbranch_scc1 qkvb0_skipw4
    v_fma_f32 v92, -v25, v244, v92
    v_mul_f32 v92, v24, v92
    v_fma_f32 v93, -v25, v245, v93
    v_mul_f32 v93, v24, v93
    v_fma_f32 v94, -v25, v246, v94
    v_mul_f32 v94, v24, v94
    v_fma_f32 v95, -v25, v247, v95
    v_mul_f32 v95, v24, v95
    v_cvt_pk_bf16_f32 v248, v92, v93
    v_cvt_pk_bf16_f32 v249, v94, v95
    ds_write_b64 v9, v[248:249] offset:30752
qkvb0_skipw4:
    s_waitcnt lgkmcnt(0)
    s_barrier
    v_and_b32 v3, 1, v2
    v_bfe_u32 v4, v2, 1, 2
    v_lshrrev_b32 v9, 3, v2
    s_lshl_b32 s24, s14, 3
    v_add_u32 v9, s24, v9
    v_mul_u32_u24 v11, 40, v4
    v_add_u32 v10, 16, v9
    v_mul_u32_u24 v10, 480, v10
    v_add_u32 v10, v10, v11
    v_lshlrev_b32 v13, 3, v3
    v_sub_u32 v14, v9, v13
    v_add_u32 v14, 10, v14
    v_mul_u32_u24 v14, 480, v14
    v_add_u32 v14, v14, v11
    s_lshl_b32 s24, s12, 6
    v_add_u32 v9, s24, v9
    v_sub_u32 v13, v9, v13
    ds_read_b64 v[16:17], v10 offset:0
    ds_read_b64 v[18:19], v10 offset:8
    ds_read_b64 v[20:21], v10 offset:16
    ds_read_b64 v[22:23], v10 offset:24
    ds_read_b64 v[24:25], v10 offset:32
    ds_read_b64 v[96:97], v14 offset:3040
    ds_read_b64 v[98:99], v14 offset:3048
    ds_read_b64 v[100:101], v14 offset:3056
    ds_read_b64 v[102:103], v14 offset:3064
    ds_read_b64 v[104:105], v14 offset:3072
    ds_read_b64 v[106:107], v14 offset:2080
    ds_read_b64 v[108:109], v14 offset:2088
    ds_read_b64 v[110:111], v14 offset:2096
    ds_read_b64 v[112:113], v14 offset:2104
    ds_read_b64 v[114:115], v14 offset:2112
    s_waitcnt lgkmcnt(5)
    ds_read_b64 v[116:117], v14 offset:1120
    ds_read_b64 v[118:119], v14 offset:1128
    ds_read_b64 v[120:121], v14 offset:1136
    ds_read_b64 v[122:123], v14 offset:1144
    ds_read_b64 v[124:125], v14 offset:1152
    ds_read_b64 v[126:127], v14 offset:160
    ds_read_b64 v[128:129], v14 offset:168
    ds_read_b64 v[130:131], v14 offset:176
    ds_read_b64 v[132:133], v14 offset:184
    ds_read_b64 v[134:135], v14 offset:192
    s_waitcnt lgkmcnt(5)
    ds_read_b64 v[136:137], v14 offset:3200
    ds_read_b64 v[138:139], v14 offset:3208
    ds_read_b64 v[140:141], v14 offset:3216
    ds_read_b64 v[142:143], v14 offset:3224
    ds_read_b64 v[144:145], v14 offset:3232
    ds_read_b64 v[146:147], v14 offset:2240
    ds_read_b64 v[148:149], v14 offset:2248
    ds_read_b64 v[150:151], v14 offset:2256
    ds_read_b64 v[152:153], v14 offset:2264
    ds_read_b64 v[154:155], v14 offset:2272
    s_waitcnt lgkmcnt(10)
    ds_read_b64 v[156:157], v14 offset:1280
    ds_read_b64 v[158:159], v14 offset:1288
    ds_read_b64 v[160:161], v14 offset:1296
    ds_read_b64 v[162:163], v14 offset:1304
    ds_read_b64 v[164:165], v14 offset:1312
    ds_read_b64 v[166:167], v14 offset:320
    ds_read_b64 v[168:169], v14 offset:328
    ds_read_b64 v[170:171], v14 offset:336
    ds_read_b64 v[172:173], v14 offset:344
    ds_read_b64 v[174:175], v14 offset:352
    v_mov_b32 v32, 0
    v_mov_b32 v33, 0
    v_mov_b32 v34, 0
    v_mov_b32 v35, 0
    s_waitcnt lgkmcnt(15)
    v_dot2_f32_bf16 v32, v16, v96, v32
    v_dot2_f32_bf16 v33, v16, v106, v33
    v_dot2_f32_bf16 v34, v16, v116, v34
    v_dot2_f32_bf16 v35, v16, v126, v35
    v_dot2_f32_bf16 v32, v17, v97, v32
    v_dot2_f32_bf16 v33, v17, v107, v33
    v_dot2_f32_bf16 v34, v17, v117, v34
    v_dot2_f32_bf16 v35, v17, v127, v35
    v_dot2_f32_bf16 v32, v18, v98, v32
    v_dot2_f32_bf16 v33, v18, v108, v33
    v_dot2_f32_bf16 v34, v18, v118, v34
    v_dot2_f32_bf16 v35, v18, v128, v35
    v_dot2_f32_bf16 v32, v19, v99, v32
    v_dot2_f32_bf16 v33, v19, v109, v33
    v_dot2_f32_bf16 v34, v19, v119, v34
    v_dot2_f32_bf16 v35, v19, v129, v35
    v_dot2_f32_bf16 v32, v20, v100, v32
    v_dot2_f32_bf16 v33, v20, v110, v33
    v_dot2_f32_bf16 v34, v20, v120, v34
    v_dot2_f32_bf16 v35, v20, v130, v35
    v_dot2_f32_bf16 v32, v21, v101, v32
    v_dot2_f32_bf16 v33, v21, v111, v33
    v_dot2_f32_bf16 v34, v21, v121, v34
    v_dot2_f32_bf16 v35, v21, v131, v35
    v_dot2_f32_bf16 v32, v22, v102, v32
    v_dot2_f32_bf16 v33, v22, v112, v33
    v_dot2_f32_bf16 v34, v22, v122, v34
    v_dot2_f32_bf16 v35, v22, v132, v35
    v_dot2_f32_bf16 v32, v23, v103, v32
    v_dot2_f32_bf16 v33, v23, v113, v33
    v_dot2_f32_bf16 v34, v23, v123, v34
    v_dot2_f32_bf16 v35, v23, v133, v35
    v_dot2_f32_bf16 v32, v24, v104, v32
    v_dot2_f32_bf16 v33, v24, v114, v33
    v_dot2_f32_bf16 v34, v24, v124, v34
    v_dot2_f32_bf16 v35, v24, v134, v35
    s_mov_b32 s37, 0x3eae1a93
    v_mov_b32 v12, 0xf149f2ca
    s_nop 1
    v_mul_f32 v32, s37, v32
    v_cmp_le_i32 vcc, 0, v13
    s_nop 1
    v_cndmask_b32 v32, v12, v32, vcc
    v_mul_f32 v33, s37, v33
    v_cmp_le_i32 vcc, 2, v13
    s_nop 1
    v_cndmask_b32 v33, v12, v33, vcc
    v_mul_f32 v34, s37, v34
    v_cmp_le_i32 vcc, 4, v13
    s_nop 1
    v_cndmask_b32 v34, v12, v34, vcc
    v_mul_f32 v35, s37, v35
    v_cmp_le_i32 vcc, 6, v13
    s_nop 1
    v_cndmask_b32 v35, v12, v35, vcc
    v_max3_f32 v15, v32, v33, v34
    v_max_f32 v15, v15, v35
    s_nop 1
    v_max_f32_dpp v15, v15, v15 quad_perm:[1,0,3,2] row_mask:0xf bank_mask:0xf
    v_sub_f32 v32, v32, v15
    v_sub_f32 v33, v33, v15
    v_sub_f32 v34, v34, v15
    v_sub_f32 v35, v35, v15
    v_exp_f32 v32, v32
    v_exp_f32 v33, v33
    v_exp_f32 v34, v34
    v_exp_f32 v35, v35
    s_nop 0
    v_add_f32 v15, v32, v33
    v_add_f32 v26, v34, v35
    v_add_f32 v15, v15, v26
    s_nop 1
    v_add_f32_dpp v15, v15, v15 quad_perm:[1,0,3,2] row_mask:0xf bank_mask:0xf
    v_rcp_f32 v15, v15
    s_waitcnt lgkmcnt(0)
    v_mul_f32 v32, v32, v15
    v_mul_f32 v33, v33, v15
    v_mul_f32 v34, v34, v15
    v_mul_f32 v35, v35, v15
    v_lshlrev_b32 v58, 16, v136
    v_and_b32 v59, 0xffff0000, v136
    v_mul_f32 v40, v32, v58
    v_mul_f32 v41, v32, v59
    v_lshlrev_b32 v58, 16, v146
    v_and_b32 v59, 0xffff0000, v146
    v_fmac_f32 v40, v33, v58
    v_fmac_f32 v41, v33, v59
    v_lshlrev_b32 v58, 16, v156
    v_and_b32 v59, 0xffff0000, v156
    v_fmac_f32 v40, v34, v58
    v_fmac_f32 v41, v34, v59
    v_lshlrev_b32 v58, 16, v166
    v_and_b32 v59, 0xffff0000, v166
    v_fmac_f32 v40, v35, v58
    v_fmac_f32 v41, v35, v59
    v_lshlrev_b32 v58, 16, v137
    v_and_b32 v59, 0xffff0000, v137
    v_mul_f32 v42, v32, v58
    v_mul_f32 v43, v32, v59
    v_lshlrev_b32 v58, 16, v147
    v_and_b32 v59, 0xffff0000, v147
    v_fmac_f32 v42, v33, v58
    v_fmac_f32 v43, v33, v59
    v_lshlrev_b32 v58, 16, v157
    v_and_b32 v59, 0xffff0000, v157
    v_fmac_f32 v42, v34, v58
    v_fmac_f32 v43, v34, v59
    v_lshlrev_b32 v58, 16, v167
    v_and_b32 v59, 0xffff0000, v167
    v_fmac_f32 v42, v35, v58
    v_fmac_f32 v43, v35, v59
    v_lshlrev_b32 v58, 16, v138
    v_and_b32 v59, 0xffff0000, v138
    v_mul_f32 v44, v32, v58
    v_mul_f32 v45, v32, v59
    v_lshlrev_b32 v58, 16, v148
    v_and_b32 v59, 0xffff0000, v148
    v_fmac_f32 v44, v33, v58
    v_fmac_f32 v45, v33, v59
    v_lshlrev_b32 v58, 16, v158
    v_and_b32 v59, 0xffff0000, v158
    v_fmac_f32 v44, v34, v58
    v_fmac_f32 v45, v34, v59
    v_lshlrev_b32 v58, 16, v168
    v_and_b32 v59, 0xffff0000, v168
    v_fmac_f32 v44, v35, v58
    v_fmac_f32 v45, v35, v59
    v_lshlrev_b32 v58, 16, v139
    v_and_b32 v59, 0xffff0000, v139
    v_mul_f32 v46, v32, v58
    v_mul_f32 v47, v32, v59
    v_lshlrev_b32 v58, 16, v149
    v_and_b32 v59, 0xffff0000, v149
    v_fmac_f32 v46, v33, v58
    v_fmac_f32 v47, v33, v59
    v_lshlrev_b32 v58, 16, v159
    v_and_b32 v59, 0xffff0000, v159
    v_fmac_f32 v46, v34, v58
    v_fmac_f32 v47, v34, v59
    v_lshlrev_b32 v58, 16, v169
    v_and_b32 v59, 0xffff0000, v169
    v_fmac_f32 v46, v35, v58
    v_fmac_f32 v47, v35, v59
    v_lshlrev_b32 v58, 16, v140
    v_and_b32 v59, 0xffff0000, v140
    v_mul_f32 v48, v32, v58
    v_mul_f32 v49, v32, v59
    v_lshlrev_b32 v58, 16, v150
    v_and_b32 v59, 0xffff0000, v150
    v_fmac_f32 v48, v33, v58
    v_fmac_f32 v49, v33, v59
    v_lshlrev_b32 v58, 16, v160
    v_and_b32 v59, 0xffff0000, v160
    v_fmac_f32 v48, v34, v58
    v_fmac_f32 v49, v34, v59
    v_lshlrev_b32 v58, 16, v170
    v_and_b32 v59, 0xffff0000, v170
    v_fmac_f32 v48, v35, v58
    v_fmac_f32 v49, v35, v59
    v_lshlrev_b32 v58, 16, v141
    v_and_b32 v59, 0xffff0000, v141
    v_mul_f32 v50, v32, v58
    v_mul_f32 v51, v32, v59
    v_lshlrev_b32 v58, 16, v151
    v_and_b32 v59, 0xffff0000, v151
    v_fmac_f32 v50, v33, v58
    v_fmac_f32 v51, v33, v59
    v_lshlrev_b32 v58, 16, v161
    v_and_b32 v59, 0xffff0000, v161
    v_fmac_f32 v50, v34, v58
    v_fmac_f32 v51, v34, v59
    v_lshlrev_b32 v58, 16, v171
    v_and_b32 v59, 0xffff0000, v171
    v_fmac_f32 v50, v35, v58
    v_fmac_f32 v51, v35, v59
    v_lshlrev_b32 v58, 16, v142
    v_and_b32 v59, 0xffff0000, v142
    v_mul_f32 v52, v32, v58
    v_mul_f32 v53, v32, v59
    v_lshlrev_b32 v58, 16, v152
    v_and_b32 v59, 0xffff0000, v152
    v_fmac_f32 v52, v33, v58
    v_fmac_f32 v53, v33, v59
    v_lshlrev_b32 v58, 16, v162
    v_and_b32 v59, 0xffff0000, v162
    v_fmac_f32 v52, v34, v58
    v_fmac_f32 v53, v34, v59
    v_lshlrev_b32 v58, 16, v172
    v_and_b32 v59, 0xffff0000, v172
    v_fmac_f32 v52, v35, v58
    v_fmac_f32 v53, v35, v59
    v_lshlrev_b32 v58, 16, v143
    v_and_b32 v59, 0xffff0000, v143
    v_mul_f32 v54, v32, v58
    v_mul_f32 v55, v32, v59
    v_lshlrev_b32 v58, 16, v153
    v_and_b32 v59, 0xffff0000, v153
    v_fmac_f32 v54, v33, v58
    v_fmac_f32 v55, v33, v59
    v_lshlrev_b32 v58, 16, v163
    v_and_b32 v59, 0xffff0000, v163
    v_fmac_f32 v54, v34, v58
    v_fmac_f32 v55, v34, v59
    v_lshlrev_b32 v58, 16, v173
    v_and_b32 v59, 0xffff0000, v173
    v_fmac_f32 v54, v35, v58
    v_fmac_f32 v55, v35, v59
    v_lshlrev_b32 v58, 16, v144
    v_and_b32 v59, 0xffff0000, v144
    v_mul_f32 v56, v32, v58
    v_mul_f32 v57, v32, v59
    v_lshlrev_b32 v58, 16, v154
    v_and_b32 v59, 0xffff0000, v154
    v_fmac_f32 v56, v33, v58
    v_fmac_f32 v57, v33, v59
    v_lshlrev_b32 v58, 16, v164
    v_and_b32 v59, 0xffff0000, v164
    v_fmac_f32 v56, v34, v58
    v_fmac_f32 v57, v34, v59
    v_lshlrev_b32 v58, 16, v174
    v_and_b32 v59, 0xffff0000, v174
    v_fmac_f32 v56, v35, v58
    v_fmac_f32 v57, v35, v59
    s_nop 1
    v_add_f32_dpp v40, v40, v40 quad_perm:[1,0,3,2] row_mask:0xf bank_mask:0xf
    v_add_f32_dpp v41, v41, v41 quad_perm:[1,0,3,2] row_mask:0xf bank_mask:0xf
    v_add_f32_dpp v42, v42, v42 quad_perm:[1,0,3,2] row_mask:0xf bank_mask:0xf
    v_add_f32_dpp v43, v43, v43 quad_perm:[1,0,3,2] row_mask:0xf bank_mask:0xf
    v_add_f32_dpp v44, v44, v44 quad_perm:[1,0,3,2] row_mask:0xf bank_mask:0xf
    v_add_f32_dpp v45, v45, v45 quad_perm:[1,0,3,2] row_mask:0xf bank_mask:0xf
    v_add_f32_dpp v46, v46, v46 quad_perm:[1,0,3,2] row_mask:0xf bank_mask:0xf
    v_add_f32_dpp v47, v47, v47 quad_perm:[1,0,3,2] row_mask:0xf bank_mask:0xf
    v_add_f32_dpp v48, v48, v48 quad_perm:[1,0,3,2] row_mask:0xf bank_mask:0xf
    v_add_f32_dpp v49, v49, v49 quad_perm:[1,0,3,2] row_mask:0xf bank_mask:0xf
    v_add_f32_dpp v50, v50, v50 quad_perm:[1,0,3,2] row_mask:0xf bank_mask:0xf
    v_add_f32_dpp v51, v51, v51 quad_perm:[1,0,3,2] row_mask:0xf bank_mask:0xf
    v_add_f32_dpp v52, v52, v52 quad_perm:[1,0,3,2] row_mask:0xf bank_mask:0xf
    v_add_f32_dpp v53, v53, v53 quad_perm:[1,0,3,2] row_mask:0xf bank_mask:0xf
    v_add_f32_dpp v54, v54, v54 quad_perm:[1,0,3,2] row_mask:0xf bank_mask:0xf
    v_add_f32_dpp v55, v55, v55 quad_perm:[1,0,3,2] row_mask:0xf bank_mask:0xf
    v_add_f32_dpp v56, v56, v56 quad_perm:[1,0,3,2] row_mask:0xf bank_mask:0xf
    v_add_f32_dpp v57, v57, v57 quad_perm:[1,0,3,2] row_mask:0xf bank_mask:0xf
    v_cvt_pk_bf16_f32 v60, v40, v41
    v_cvt_pk_bf16_f32 v61, v42, v43
    v_cvt_pk_bf16_f32 v62, v44, v45
    v_cvt_pk_bf16_f32 v63, v46, v47
    v_cvt_pk_bf16_f32 v64, v48, v49
    v_cvt_pk_bf16_f32 v65, v50, v51
    v_cvt_pk_bf16_f32 v66, v52, v53
    v_cvt_pk_bf16_f32 v67, v54, v55
    v_cvt_pk_bf16_f32 v68, v56, v57
    v_mul_u32_u24 v9, 1152, v9
    v_mul_u32_u24 v11, 36, v4
    v_add_u32 v9, v9, v11
    s_mul_i32 s24, s13, 144
    s_add_u32 s24, s24, 8388608
    v_cmp_eq_u32 vcc, 0, v3
    s_and_saveexec_b64 s[38:39], vcc
    buffer_store_dwordx4 v[60:63], v9, s[20:23], s24 offen
    buffer_store_dwordx4 v[64:67], v9, s[20:23], s24 offen offset:16
    buffer_store_dword v68, v9, s[20:23], s24 offen offset:32
    s_mov_b64 exec, s[38:39]
qkvb0_end:
    s_endpgm
.globl ob0_kernel
.type ob0_kernel,@function
.p2align 8
ob0_kernel:
    s_cmp_ge_u32 s2, 256
    s_cbranch_scc1 ob0_end
    s_load_dwordx2 s[4:5], s[0:1], 80
    s_load_dwordx2 s[6:7], s[0:1], 80
    s_load_dwordx2 s[8:9], s[0:1], 80
    s_load_dwordx2 s[10:11], s[0:1], 80
    s_and_b32 s12, s2, 63
    s_lshr_b32 s13, s2, 6
    v_lshrrev_b32 v1, 6, v0
    v_and_b32 v2, 63, v0
    v_and_b32 v3, 15, v2
    v_readfirstlane_b32 s14, v1
    v_lshrrev_b32 v4, 4, v2
    v_mul_u32_u24 v5, 1152, v3
    v_lshl_add_u32 v5, v4, 4, v5
    v_lshlrev_b32 v6, 4, v2
    s_mul_i32 s15, s12, 36864
    s_lshl_b32 s26, s12, 5
    s_waitcnt lgkmcnt(0)
    s_add_u32 s16, s4, 8388608
    s_addc_u32 s17, s5, 0
    s_mov_b32 s18, 2359296
    s_mov_b32 s19, 0x00020000
    s_mov_b32 s20, s6
    s_mov_b32 s21, s7
    s_mov_b32 s22, 268435456
    s_mov_b32 s23, 0x00020000
    s_mov_b32 s40, s14
    s_mul_i32 s41, s40, 57
    s_lshr_b32 s41, s41, 10
    s_mul_i32 s42, s41, 18
    s_sub_u32 s42, s40, s42
    s_lshl_b32 s42, s42, 6
    s_mul_i32 s41, s41, 18432
    s_add_u32 s42, s42, s41
    s_add_u32 s42, s42, s15
    s_lshl_b32 s43, s40, 10
    s_mov_b32 m0, s43
    s_add_u32 s40, s40, 9
    buffer_load_dwordx4 v5, s[16:19], s42 offen lds
    s_mul_i32 s41, s40, 57
    s_lshr_b32 s41, s41, 10
    s_mul_i32 s42, s41, 18
    s_sub_u32 s42, s40, s42
    s_lshl_b32 s42, s42, 6
    s_mul_i32 s41, s41, 18432
    s_add_u32 s42, s42, s41
    s_add_u32 s42, s42, s15
    s_lshl_b32 s43, s40, 10
    s_mov_b32 m0, s43
    s_add_u32 s40, s40, 9
    buffer_load_dwordx4 v5, s[16:19], s42 offen lds
    s_mul_i32 s41, s40, 57
    s_lshr_b32 s41, s41, 10
    s_mul_i32 s42, s41, 18
    s_sub_u32 s42, s40, s42
    s_lshl_b32 s42, s42, 6
    s_mul_i32 s41, s41, 18432
    s_add_u32 s42, s42, s41
    s_add_u32 s42, s42, s15
    s_lshl_b32 s43, s40, 10
    s_mov_b32 m0, s43
    s_add_u32 s40, s40, 9
    buffer_load_dwordx4 v5, s[16:19], s42 offen lds
    s_mul_i32 s41, s40, 57
    s_lshr_b32 s41, s41, 10
    s_mul_i32 s42, s41, 18
    s_sub_u32 s42, s40, s42
    s_lshl_b32 s42, s42, 6
    s_mul_i32 s41, s41, 18432
    s_add_u32 s42, s42, s41
    s_add_u32 s42, s42, s15
    s_lshl_b32 s43, s40, 10
    s_mov_b32 m0, s43
    s_add_u32 s40, s40, 9
    buffer_load_dwordx4 v5, s[16:19], s42 offen lds
ob0_dmadone:
    s_barrier
    s_mul_i32 s24, s13, 9
    s_add_u32 s24, s24, s14
    s_mul_i32 s25, s24, 18432
    s_add_u32 s25, s25, 1572864
    buffer_load_dwordx4 v[56:59], v6, s[20:23], s25 offen offset:0
    buffer_load_dwordx4 v[60:63], v6, s[20:23], s25 offen offset:1024
    buffer_load_dwordx4 v[64:67], v6, s[20:23], s25 offen offset:2048
    buffer_load_dwordx4 v[68:71], v6, s[20:23], s25 offen offset:3072
    s_add_u32 s25, s25, 4096
    buffer_load_dwordx4 v[72:75], v6, s[20:23], s25 offen offset:0
    buffer_load_dwordx4 v[76:79], v6, s[20:23], s25 offen offset:1024
    buffer_load_dwordx4 v[80:83], v6, s[20:23], s25 offen offset:2048
    buffer_load_dwordx4 v[84:87], v6, s[20:23], s25 offen offset:3072
    s_add_u32 s25, s25, 4096
    buffer_load_dwordx4 v[88:91], v6, s[20:23], s25 offen offset:0
    v_add_u32 v7, s26, v3
    s_lshl_b32 s27, s24, 4
    v_lshl_add_u32 v10, v4, 2, s27
    v_mul_u32_u24 v8, 1152, v7
    v_lshl_add_u32 v8, v10, 1, v8
    v_add_u32 v9, 18432, v8
    s_add_u32 s28, s8, 11534336
    s_addc_u32 s29, s9, 0
    s_mov_b32 s30, 2359296
    s_mov_b32 s31, 0x00020000
    s_add_u32 s32, s10, 14680064
    s_addc_u32 s33, s11, 0
    s_mov_b32 s34, 2359296
    s_mov_b32 s35, 0x00020000
    buffer_load_dwordx2 v[148:149], v8, s[28:31], 0 offen
    buffer_load_dwordx2 v[150:151], v9, s[28:31], 0 offen
    s_waitcnt vmcnt(11)
    s_barrier
    v_mov_b32 v48, 0
    v_mov_b32 v49, 0
    v_mov_b32 v50, 0
    v_mov_b32 v51, 0
    v_mov_b32 v52, 0
    v_mov_b32 v53, 0
    v_mov_b32 v54, 0
    v_mov_b32 v55, 0
    ds_read_b128 v[16:19], v6 offset:0
    ds_read_b128 v[20:23], v6 offset:18432
    ds_read_b128 v[24:27], v6 offset:1024
    ds_read_b128 v[28:31], v6 offset:19456
    ds_read_b128 v[32:35], v6 offset:2048
    ds_read_b128 v[36:39], v6 offset:20480
    ds_read_b128 v[40:43], v6 offset:3072
    ds_read_b128 v[44:47], v6 offset:21504
    buffer_load_dwordx4 v[92:95], v6, s[20:23], s25 offen offset:1024
    s_waitcnt vmcnt(11) lgkmcnt(6)
    v_mfma_f32_16x16x32_bf16 v[48:51], v[56:59], v[16:19], v[48:51]
    v_mfma_f32_16x16x32_bf16 v[52:55], v[56:59], v[20:23], v[52:55]
    ds_read_b128 v[16:19], v6 offset:4096
    ds_read_b128 v[20:23], v6 offset:22528
    buffer_load_dwordx4 v[96:99], v6, s[20:23], s25 offen offset:2048
    s_waitcnt vmcnt(11) lgkmcnt(6)
    v_mfma_f32_16x16x32_bf16 v[48:51], v[60:63], v[24:27], v[48:51]
    v_mfma_f32_16x16x32_bf16 v[52:55], v[60:63], v[28:31], v[52:55]
    ds_read_b128 v[24:27], v6 offset:5120
    ds_read_b128 v[28:31], v6 offset:23552
    buffer_load_dwordx4 v[100:103], v6, s[20:23], s25 offen offset:3072
    s_waitcnt vmcnt(11) lgkmcnt(6)
    v_mfma_f32_16x16x32_bf16 v[48:51], v[64:67], v[32:35], v[48:51]
    v_mfma_f32_16x16x32_bf16 v[52:55], v[64:67], v[36:39], v[52:55]
    ds_read_b128 v[32:35], v6 offset:6144
    ds_read_b128 v[36:39], v6 offset:24576
    s_add_u32 s25, s25, 4096
    buffer_load_dwordx4 v[104:107], v6, s[20:23], s25 offen offset:0
    s_waitcnt vmcnt(11) lgkmcnt(6)
    v_mfma_f32_16x16x32_bf16 v[48:51], v[68:71], v[40:43], v[48:51]
    v_mfma_f32_16x16x32_bf16 v[52:55], v[68:71], v[44:47], v[52:55]
    ds_read_b128 v[40:43], v6 offset:7168
    ds_read_b128 v[44:47], v6 offset:25600
    buffer_load_dwordx4 v[108:111], v6, s[20:23], s25 offen offset:1024
    s_waitcnt vmcnt(11) lgkmcnt(6)
    v_mfma_f32_16x16x32_bf16 v[48:51], v[72:75], v[16:19], v[48:51]
    v_mfma_f32_16x16x32_bf16 v[52:55], v[72:75], v[20:23], v[52:55]
    ds_read_b128 v[16:19], v6 offset:8192
    ds_read_b128 v[20:23], v6 offset:26624
    buffer_load_dwordx4 v[112:115], v6, s[20:23], s25 offen offset:2048
    s_waitcnt vmcnt(11) lgkmcnt(6)
    v_mfma_f32_16x16x32_bf16 v[48:51], v[76:79], v[24:27], v[48:51]
    v_mfma_f32_16x16x32_bf16 v[52:55], v[76:79], v[28:31], v[52:55]
    ds_read_b128 v[24:27], v6 offset:9216
    ds_read_b128 v[28:31], v6 offset:27648
    buffer_load_dwordx4 v[116:119], v6, s[20:23], s25 offen offset:3072
    s_waitcnt vmcnt(11) lgkmcnt(6)
    v_mfma_f32_16x16x32_bf16 v[48:51], v[80:83], v[32:35], v[48:51]
    v_mfma_f32_16x16x32_bf16 v[52:55], v[80:83], v[36:39], v[52:55]
    ds_read_b128 v[32:35], v6 offset:10240
    ds_read_b128 v[36:39], v6 offset:28672
    s_add_u32 s25, s25, 4096
    buffer_load_dwordx4 v[120:123], v6, s[20:23], s25 offen offset:0
    s_waitcnt vmcnt(11) lgkmcnt(6)
    v_mfma_f32_16x16x32_bf16 v[48:51], v[84:87], v[40:43], v[48:51]
    v_mfma_f32_16x16x32_bf16 v[52:55], v[84:87], v[44:47], v[52:55]
    ds_read_b128 v[40:43], v6 offset:11264
    ds_read_b128 v[44:47], v6 offset:29696
    buffer_load_dwordx4 v[124:127], v6, s[20:23], s25 offen offset:1024
    s_waitcnt vmcnt(11) lgkmcnt(6)
    v_mfma_f32_16x16x32_bf16 v[48:51], v[88:91], v[16:19], v[48:51]
    v_mfma_f32_16x16x32_bf16 v[52:55], v[88:91], v[20:23], v[52:55]
    ds_read_b128 v[16:19], v6 offset:12288
    ds_read_b128 v[20:23], v6 offset:30720
    s_waitcnt vmcnt(8) lgkmcnt(6)
    v_mfma_f32_16x16x32_bf16 v[48:51], v[92:95], v[24:27], v[48:51]
    v_mfma_f32_16x16x32_bf16 v[52:55], v[92:95], v[28:31], v[52:55]
    ds_read_b128 v[24:27], v6 offset:13312
    ds_read_b128 v[28:31], v6 offset:31744
    s_waitcnt vmcnt(7) lgkmcnt(6)
    v_mfma_f32_16x16x32_bf16 v[48:51], v[96:99], v[32:35], v[48:51]
    v_mfma_f32_16x16x32_bf16 v[52:55], v[96:99], v[36:39], v[52:55]
    ds_read_b128 v[32:35], v6 offset:14336
    ds_read_b128 v[36:39], v6 offset:32768
    s_waitcnt vmcnt(6) lgkmcnt(6)
    v_mfma_f32_16x16x32_bf16 v[48:51], v[100:103], v[40:43], v[48:51]
    v_mfma_f32_16x16x32_bf16 v[52:55], v[100:103], v[44:47], v[52:55]
    ds_read_b128 v[40:43], v6 offset:15360
    ds_read_b128 v[44:47], v6 offset:33792
    s_waitcnt vmcnt(5) lgkmcnt(6)
    v_mfma_f32_16x16x32_bf16 v[48:51], v[104:107], v[16:19], v[48:51]
    v_mfma_f32_16x16x32_bf16 v[52:55], v[104:107], v[20:23], v[52:55]
    ds_read_b128 v[16:19], v6 offset:16384
    ds_read_b128 v[20:23], v6 offset:34816
    s_waitcnt vmcnt(4) lgkmcnt(6)
    v_mfma_f32_16x16x32_bf16 v[48:51], v[108:111], v[24:27], v[48:51]
    v_mfma_f32_16x16x32_bf16 v[52:55], v[108:111], v[28:31], v[52:55]
    ds_read_b128 v[24:27], v6 offset:17408
    ds_read_b128 v[28:31], v6 offset:35840
    s_waitcnt vmcnt(3) lgkmcnt(6)
    v_mfma_f32_16x16x32_bf16 v[48:51], v[112:115], v[32:35], v[48:51]
    v_mfma_f32_16x16x32_bf16 v[52:55], v[112:115], v[36:39], v[52:55]
    s_waitcnt vmcnt(2) lgkmcnt(4)
    v_mfma_f32_16x16x32_bf16 v[48:51], v[116:119], v[40:43], v[48:51]
    v_mfma_f32_16x16x32_bf16 v[52:55], v[116:119], v[44:47], v[52:55]
    s_waitcnt vmcnt(1) lgkmcnt(2)
    v_mfma_f32_16x16x32_bf16 v[48:51], v[120:123], v[16:19], v[48:51]
    v_mfma_f32_16x16x32_bf16 v[52:55], v[120:123], v[20:23], v[52:55]
    s_waitcnt vmcnt(0) lgkmcnt(0)
    v_mfma_f32_16x16x32_bf16 v[48:51], v[124:127], v[24:27], v[48:51]
    v_mfma_f32_16x16x32_bf16 v[52:55], v[124:127], v[28:31], v[52:55]
    s_waitcnt vmcnt(0)
    s_nop 7
    v_mov_b32 v159, 0x3f803f80
    v_cvt_pk_bf16_f32 v152, v48, v49
    v_cvt_pk_bf16_f32 v153, v50, v51
    v_lshlrev_b32 v154, 16, v152
    v_and_b32 v155, 0xffff0000, v152
    v_lshlrev_b32 v156, 16, v153
    v_and_b32 v157, 0xffff0000, v153
    v_lshlrev_b32 v158, 16, v148
    v_and_b32 v152, 0xffff0000, v148
    v_add_f32 v154, v154, v158
    v_add_f32 v155, v155, v152
    v_lshlrev_b32 v158, 16, v149
    v_and_b32 v152, 0xffff0000, v149
    v_add_f32 v156, v156, v158
    v_add_f32 v157, v157, v152
    v_cvt_pk_bf16_f32 v148, v154, v155
    v_cvt_pk_bf16_f32 v149, v156, v157
    buffer_store_dwordx2 v[148:149], v8, s[32:35], 0 offen
    v_dot2_f32_bf16 v128, v148, v159, 0
    v_dot2_f32_bf16 v129, v148, v148, 0
    v_dot2_f32_bf16 v128, v149, v159, v128
    v_dot2_f32_bf16 v129, v149, v149, v129
    v_cvt_pk_bf16_f32 v152, v52, v53
    v_cvt_pk_bf16_f32 v153, v54, v55
    v_lshlrev_b32 v154, 16, v152
    v_and_b32 v155, 0xffff0000, v152
    v_lshlrev_b32 v156, 16, v153
    v_and_b32 v157, 0xffff0000, v153
    v_lshlrev_b32 v158, 16, v150
    v_and_b32 v152, 0xffff0000, v150
    v_add_f32 v154, v154, v158
    v_add_f32 v155, v155, v152
    v_lshlrev_b32 v158, 16, v151
    v_and_b32 v152, 0xffff0000, v151
    v_add_f32 v156, v156, v158
    v_add_f32 v157, v157, v152
    v_cvt_pk_bf16_f32 v150, v154, v155
    v_cvt_pk_bf16_f32 v151, v156, v157
    buffer_store_dwordx2 v[150:151], v9, s[32:35], 0 offen
    v_dot2_f32_bf16 v130, v150, v159, 0
    v_dot2_f32_bf16 v131, v150, v150, 0
    v_dot2_f32_bf16 v130, v151, v159, v130
    v_dot2_f32_bf16 v131, v151, v151, v131
    s_nop 2
    v_mov_b32 v152, v128
    s_nop 1
    v_permlane16_swap_b32 v128, v152
    v_add_f32 v128, v128, v152
    v_mov_b32 v152, v128
    s_nop 1
    v_permlane32_swap_b32 v128, v152
    v_add_f32 v128, v128, v152
    v_mov_b32 v152, v129
    s_nop 1
    v_permlane16_swap_b32 v129, v152
    v_add_f32 v129, v129, v152
    v_mov_b32 v152, v129
    s_nop 1
    v_permlane32_swap_b32 v129, v152
    v_add_f32 v129, v129, v152
    v_mov_b32 v152, v130
    s_nop 1
    v_permlane16_swap_b32 v130, v152
    v_add_f32 v130, v130, v152
    v_mov_b32 v152, v130
    s_nop 1
    v_permlane32_swap_b32 v130, v152
    v_add_f32 v130, v130, v152
    v_mov_b32 v152, v131
    s_nop 1
    v_permlane16_swap_b32 v131, v152
    v_add_f32 v131, v131, v152
    v_mov_b32 v152, v131
    s_nop 1
    v_permlane32_swap_b32 v131, v152
    v_add_f32 v131, v131, v152
    s_lshl_b32 s27, s14, 8
    v_lshl_add_u32 v11, v3, 3, s27
    s_mov_b64 exec, 0xffff
    ds_write_b64 v11, v[128:129] offset:36864
    ds_write_b64 v11, v[130:131] offset:36992
    s_mov_b64 exec, -1
    s_waitcnt lgkmcnt(0)
    s_barrier
    s_cmp_lg_u32 s14, 0
    s_cbranch_scc1 ob0_fin
    v_lshlrev_b32 v11, 3, v2
    ds_read_b64 v[56:57], v11 offset:36864
    ds_read_b64 v[58:59], v11 offset:37120
    ds_read_b64 v[60:61], v11 offset:37376
    ds_read_b64 v[62:63], v11 offset:37632
    ds_read_b64 v[64:65], v11 offset:37888
    ds_read_b64 v[66:67], v11 offset:38144
    ds_read_b64 v[68:69], v11 offset:38400
    ds_read_b64 v[70:71], v11 offset:38656
    ds_read_b64 v[72:73], v11 offset:38912
    s_waitcnt lgkmcnt(0)
    v_add_f32 v56, v56, v58
    v_add_f32 v57, v57, v59
    v_add_f32 v56, v56, v60
    v_add_f32 v57, v57, v61
    v_add_f32 v56, v56, v62
    v_add_f32 v57, v57, v63
    v_add_f32 v56, v56, v64
    v_add_f32 v57, v57, v65
    v_add_f32 v56, v56, v66
    v_add_f32 v57, v57, v67
    v_add_f32 v56, v56, v68
    v_add_f32 v57, v57, v69
    v_add_f32 v56, v56, v70
    v_add_f32 v57, v57, v71
    v_add_f32 v56, v56, v72
    v_add_f32 v57, v57, v73
    v_add_u32 v11, s26, v2
    v_lshlrev_b32 v11, 5, v11
    s_lshl_b32 s27, s13, 3
    s_add_u32 s27, s27, 4915200
    s_mov_b32 exec_lo, -1
    s_mov_b32 exec_hi, 0
    buffer_store_dwordx2 v[56:57], v11, s[20:23], s27 offen
    s_mov_b64 exec, -1
ob0_fin:
ob0_end:
    s_endpgm
.globl qkva1_kernel
.type qkva1_kernel,@function
.p2align 8
qkva1_kernel:
    s_cmp_ge_u32 s2, 256
    s_cbranch_scc1 qkva1_end
    s_load_dwordx2 s[4:5], s[0:1], 80
    s_load_dwordx2 s[6:7], s[0:1], 80
    s_and_b32 s12, s2, 63
    s_lshr_b32 s13, s2, 6
    v_lshrrev_b32 v1, 6, v0
    v_and_b32 v2, 63, v0
    v_and_b32 v3, 15, v2
    v_readfirstlane_b32 s14, v1
    v_lshrrev_b32 v4, 4, v2
    v_mul_u32_u24 v5, 1152, v3
    v_lshl_add_u32 v5, v4, 4, v5
    v_lshlrev_b32 v6, 4, v2
    s_mul_i32 s15, s12, 36864
    s_lshl_b32 s26, s12, 5
    s_waitcnt lgkmcnt(0)
    s_add_u32 s16, s4, 14680064
    s_addc_u32 s17, s5, 0
    s_mov_b32 s18, 2359296
    s_mov_b32 s19, 0x00020000
    s_mov_b32 s20, s6
    s_mov_b32 s21, s7
    s_mov_b32 s22, 268435456
    s_mov_b32 s23, 0x00020000
    s_cmp_lg_u32 s14, 0
    s_cbranch_scc1 qkva1_nost
    v_and_b32 v11, 31, v2
    v_add_u32 v11, s26, v11
    v_lshlrev_b32 v11, 5, v11
    v_add_u32 v11, 4915200, v11
    buffer_load_dwordx4 v[128:131], v11, s[20:23], 0 offen
    buffer_load_dwordx4 v[132:135], v11, s[20:23], 0 offen offset:16
qkva1_nost:
    s_mov_b32 s40, s14
    s_mul_i32 s41, s40, 57
    s_lshr_b32 s41, s41, 10
    s_mul_i32 s42, s41, 18
    s_sub_u32 s42, s40, s42
    s_lshl_b32 s42, s42, 6
    s_mul_i32 s41, s41, 18432
    s_add_u32 s42, s42, s41
    s_add_u32 s42, s42, s15
    s_lshl_b32 s43, s40, 10
    s_mov_b32 m0, s43
    s_add_u32 s40, s40, 10
    buffer_load_dwordx4 v5, s[16:19], s42 offen lds
    s_mul_i32 s41, s40, 57
    s_lshr_b32 s41, s41, 10
    s_mul_i32 s42, s41, 18
    s_sub_u32 s42, s40, s42
    s_lshl_b32 s42, s42, 6
    s_mul_i32 s41, s41, 18432
    s_add_u32 s42, s42, s41
    s_add_u32 s42, s42, s15
    s_lshl_b32 s43, s40, 10
    s_mov_b32 m0, s43
    s_add_u32 s40, s40, 10
    buffer_load_dwordx4 v5, s[16:19], s42 offen lds
    s_mul_i32 s41, s40, 57
    s_lshr_b32 s41, s41, 10
    s_mul_i32 s42, s41, 18
    s_sub_u32 s42, s40, s42
    s_lshl_b32 s42, s42, 6
    s_mul_i32 s41, s41, 18432
    s_add_u32 s42, s42, s41
    s_add_u32 s42, s42, s15
    s_lshl_b32 s43, s40, 10
    s_mov_b32 m0, s43
    s_add_u32 s40, s40, 10
    buffer_load_dwordx4 v5, s[16:19], s42 offen lds
    s_cmp_ge_u32 s40, 36
    s_cbranch_scc1 qkva1_dmadone
    s_mul_i32 s41, s40, 57
    s_lshr_b32 s41, s41, 10
    s_mul_i32 s42, s41, 18
    s_sub_u32 s42, s40, s42
    s_lshl_b32 s42, s42, 6
    s_mul_i32 s41, s41, 18432
    s_add_u32 s42, s42, s41
    s_add_u32 s42, s42, s15
    s_lshl_b32 s43, s40, 10
    s_mov_b32 m0, s43
    s_add_u32 s40, s40, 10
    buffer_load_dwordx4 v5, s[16:19], s42 offen lds
qkva1_dmadone:
    s_barrier
    s_mul_i32 s24, s13, 10
    s_add_u32 s24, s24, s14
    s_mul_i32 s25, s24, 18432
    s_add_u32 s25, s25, 0
    buffer_load_dwordx4 v[56:59], v6, s[20:23], s25 offen offset:0
    buffer_load_dwordx4 v[60:63], v6, s[20:23], s25 offen offset:1024
    buffer_load_dwordx4 v[64:67], v6, s[20:23], s25 offen offset:2048
    buffer_load_dwordx4 v[68:71], v6, s[20:23], s25 offen offset:3072
    s_add_u32 s25, s25, 4096
    buffer_load_dwordx4 v[72:75], v6, s[20:23], s25 offen offset:0
    buffer_load_dwordx4 v[76:79], v6, s[20:23], s25 offen offset:1024
    buffer_load_dwordx4 v[80:83], v6, s[20:23], s25 offen offset:2048
    buffer_load_dwordx4 v[84:87], v6, s[20:23], s25 offen offset:3072
    s_add_u32 s25, s25, 4096
    buffer_load_dwordx4 v[88:91], v6, s[20:23], s25 offen offset:0
    v_add_u32 v7, s26, v3
    s_lshl_b32 s27, s24, 4
    v_lshl_add_u32 v10, v4, 2, s27
    v_mul_u32_u24 v8, 1152, v7
    v_lshl_add_u32 v8, v10, 1, v8
    v_add_u32 v9, 18432, v8
    v_lshlrev_b32 v12, 2, v10
    v_add_u32 v12, 4653056, v12
    buffer_load_dwordx4 v[144:147], v12, s[20:23], 0 offen
    s_mov_b32 s27, 16384
    s_mov_b32 s28, 32768
    buffer_load_dwordx4 v[148:151], v12, s[20:23], s27 offen
    buffer_load_dwordx4 v[136:139], v12, s[20:23], s28 offen
    s_waitcnt vmcnt(12)
    s_cmp_lg_u32 s14, 0
    s_cbranch_scc1 qkva1_nost2
    v_add_f32 v128, v128, v130
    v_add_f32 v129, v129, v131
    v_add_f32 v132, v132, v134
    v_add_f32 v133, v133, v135
    v_add_f32 v128, v128, v132
    v_add_f32 v129, v129, v133
    v_mul_f32 v128, 0x3ae38e39, v128
    v_mul_f32 v129, 0x3ae38e39, v129
    v_fma_f32 v129, -v128, v128, v129
    v_max_f32 v129, 0, v129
    v_cvt_pk_bf16_f32 v152, v128, v129
    v_and_b32 v130, 0xffff0000, v152
    v_lshlrev_b32 v129, 16, v152
    v_add_f32 v130, 0x3727c5ac, v130
    v_cvt_pk_bf16_f32 v152, v130, v130
    v_lshlrev_b32 v130, 16, v152
    v_sqrt_f32 v130, v130
    s_nop 0
    v_cvt_pk_bf16_f32 v152, v130, v130
    v_lshlrev_b32 v130, 16, v152
    v_rcp_f32 v128, v130
    s_nop 0
    v_lshlrev_b32 v11, 3, v2
    s_mov_b32 exec_lo, -1
    s_mov_b32 exec_hi, 0
    ds_write_b64 v11, v[128:129] offset:36864
    s_mov_b64 exec, -1
    s_waitcnt lgkmcnt(0)
qkva1_nost2:
    s_barrier
    v_mov_b32 v48, 0
    v_mov_b32 v49, 0
    v_mov_b32 v50, 0
    v_mov_b32 v51, 0
    v_mov_b32 v52, 0
    v_mov_b32 v53, 0
    v_mov_b32 v54, 0
    v_mov_b32 v55, 0
    v_lshlrev_b32 v11, 3, v3
    ds_read_b64 v[128:129], v11 offset:36864
    ds_read_b64 v[130:131], v11 offset:36992
    ds_read_b128 v[16:19], v6 offset:0
    ds_read_b128 v[20:23], v6 offset:18432
    ds_read_b128 v[24:27], v6 offset:1024
    ds_read_b128 v[28:31], v6 offset:19456
    ds_read_b128 v[32:35], v6 offset:2048
    ds_read_b128 v[36:39], v6 offset:20480
    ds_read_b128 v[40:43], v6 offset:3072
    ds_read_b128 v[44:47], v6 offset:21504
    buffer_load_dwordx4 v[92:95], v6, s[20:23], s25 offen offset:1024
    s_waitcnt vmcnt(12) lgkmcnt(6)
    v_mfma_f32_16x16x32_bf16 v[48:51], v[56:59], v[16:19], v[48:51]
    v_mfma_f32_16x16x32_bf16 v[52:55], v[56:59], v[20:23], v[52:55]
    ds_read_b128 v[16:19], v6 offset:4096
    ds_read_b128 v[20:23], v6 offset:22528
    buffer_load_dwordx4 v[96:99], v6, s[20:23], s25 offen offset:2048
    s_waitcnt vmcnt(12) lgkmcnt(6)
    v_mfma_f32_16x16x32_bf16 v[48:51], v[60:63], v[24:27], v[48:51]
    v_mfma_f32_16x16x32_bf16 v[52:55], v[60:63], v[28:31], v[52:55]
    ds_read_b128 v[24:27], v6 offset:5120
    ds_read_b128 v[28:31], v6 offset:23552
    buffer_load_dwordx4 v[100:103], v6, s[20:23], s25 offen offset:3072
    s_waitcnt vmcnt(12) lgkmcnt(6)
    v_mfma_f32_16x16x32_bf16 v[48:51], v[64:67], v[32:35], v[48:51]
    v_mfma_f32_16x16x32_bf16 v[52:55], v[64:67], v[36:39], v[52:55]
    ds_read_b128 v[32:35], v6 offset:6144
    ds_read_b128 v[36:39], v6 offset:24576
    s_add_u32 s25, s25, 4096
    buffer_load_dwordx4 v[104:107], v6, s[20:23], s25 offen offset:0
    s_waitcnt vmcnt(12) lgkmcnt(6)
    v_mfma_f32_16x16x32_bf16 v[48:51], v[68:71], v[40:43], v[48:51]
    v_mfma_f32_16x16x32_bf16 v[52:55], v[68:71], v[44:47], v[52:55]
    ds_read_b128 v[40:43], v6 offset:7168
    ds_read_b128 v[44:47], v6 offset:25600
    buffer_load_dwordx4 v[108:111], v6, s[20:23], s25 offen offset:1024
    s_waitcnt vmcnt(12) lgkmcnt(6)
    v_mfma_f32_16x16x32_bf16 v[48:51], v[72:75], v[16:19], v[48:51]
    v_mfma_f32_16x16x32_bf16 v[52:55], v[72:75], v[20:23], v[52:55]
    ds_read_b128 v[16:19], v6 offset:8192
    ds_read_b128 v[20:23], v6 offset:26624
    buffer_load_dwordx4 v[112:115], v6, s[20:23], s25 offen offset:2048
    s_waitcnt vmcnt(12) lgkmcnt(6)
    v_mfma_f32_16x16x32_bf16 v[48:51], v[76:79], v[24:27], v[48:51]
    v_mfma_f32_16x16x32_bf16 v[52:55], v[76:79], v[28:31], v[52:55]
    ds_read_b128 v[24:27], v6 offset:9216
    ds_read_b128 v[28:31], v6 offset:27648
    buffer_load_dwordx4 v[116:119], v6, s[20:23], s25 offen offset:3072
    s_waitcnt vmcnt(12) lgkmcnt(6)
    v_mfma_f32_16x16x32_bf16 v[48:51], v[80:83], v[32:35], v[48:51]
    v_mfma_f32_16x16x32_bf16 v[52:55], v[80:83], v[36:39], v[52:55]
    ds_read_b128 v[32:35], v6 offset:10240
    ds_read_b128 v[36:39], v6 offset:28672
    s_add_u32 s25, s25, 4096
    buffer_load_dwordx4 v[120:123], v6, s[20:23], s25 offen offset:0
    s_waitcnt vmcnt(12) lgkmcnt(6)
    v_mfma_f32_16x16x32_bf16 v[48:51], v[84:87], v[40:43], v[48:51]
    v_mfma_f32_16x16x32_bf16 v[52:55], v[84:87], v[44:47], v[52:55]
    ds_read_b128 v[40:43], v6 offset:11264
    ds_read_b128 v[44:47], v6 offset:29696
    buffer_load_dwordx4 v[124:127], v6, s[20:23], s25 offen offset:1024
    s_waitcnt vmcnt(12) lgkmcnt(6)
    v_mfma_f32_16x16x32_bf16 v[48:51], v[88:91], v[16:19], v[48:51]
    v_mfma_f32_16x16x32_bf16 v[52:55], v[88:91], v[20:23], v[52:55]
    ds_read_b128 v[16:19], v6 offset:12288
    ds_read_b128 v[20:23], v6 offset:30720
    s_waitcnt vmcnt(8) lgkmcnt(6)
    v_mfma_f32_16x16x32_bf16 v[48:51], v[92:95], v[24:27], v[48:51]
    v_mfma_f32_16x16x32_bf16 v[52:55], v[92:95], v[28:31], v[52:55]
    ds_read_b128 v[24:27], v6 offset:13312
    ds_read_b128 v[28:31], v6 offset:31744
    s_waitcnt vmcnt(7) lgkmcnt(6)
    v_mfma_f32_16x16x32_bf16 v[48:51], v[96:99], v[32:35], v[48:51]
    v_mfma_f32_16x16x32_bf16 v[52:55], v[96:99], v[36:39], v[52:55]
    ds_read_b128 v[32:35], v6 offset:14336
    ds_read_b128 v[36:39], v6 offset:32768
    s_waitcnt vmcnt(6) lgkmcnt(6)
    v_mfma_f32_16x16x32_bf16 v[48:51], v[100:103], v[40:43], v[48:51]
    v_mfma_f32_16x16x32_bf16 v[52:55], v[100:103], v[44:47], v[52:55]
    ds_read_b128 v[40:43], v6 offset:15360
    ds_read_b128 v[44:47], v6 offset:33792
    s_waitcnt vmcnt(5) lgkmcnt(6)
    v_mfma_f32_16x16x32_bf16 v[48:51], v[104:107], v[16:19], v[48:51]
    v_mfma_f32_16x16x32_bf16 v[52:55], v[104:107], v[20:23], v[52:55]
    ds_read_b128 v[16:19], v6 offset:16384
    ds_read_b128 v[20:23], v6 offset:34816
    s_waitcnt vmcnt(4) lgkmcnt(6)
    v_mfma_f32_16x16x32_bf16 v[48:51], v[108:111], v[24:27], v[48:51]
    v_mfma_f32_16x16x32_bf16 v[52:55], v[108:111], v[28:31], v[52:55]
    ds_read_b128 v[24:27], v6 offset:17408
    ds_read_b128 v[28:31], v6 offset:35840
    s_waitcnt vmcnt(3) lgkmcnt(6)
    v_mfma_f32_16x16x32_bf16 v[48:51], v[112:115], v[32:35], v[48:51]
    v_mfma_f32_16x16x32_bf16 v[52:55], v[112:115], v[36:39], v[52:55]
    s_waitcnt vmcnt(2) lgkmcnt(4)
    v_mfma_f32_16x16x32_bf16 v[48:51], v[116:119], v[40:43], v[48:51]
    v_mfma_f32_16x16x32_bf16 v[52:55], v[116:119], v[44:47], v[52:55]
    s_waitcnt vmcnt(1) lgkmcnt(2)
    v_mfma_f32_16x16x32_bf16 v[48:51], v[120:123], v[16:19], v[48:51]
    v_mfma_f32_16x16x32_bf16 v[52:55], v[120:123], v[20:23], v[52:55]
    s_waitcnt vmcnt(0) lgkmcnt(0)
    v_mfma_f32_16x16x32_bf16 v[48:51], v[124:127], v[24:27], v[48:51]
    v_mfma_f32_16x16x32_bf16 v[52:55], v[124:127], v[28:31], v[52:55]
    s_waitcnt vmcnt(0)
    s_nop 7
    v_add_f32 v144, v144, v148
    v_add_f32 v144, v144, v136
    v_add_f32 v145, v145, v149
    v_add_f32 v145, v145, v137
    v_add_f32 v146, v146, v150
    v_add_f32 v146, v146, v138
    v_add_f32 v147, v147, v151
    v_add_f32 v147, v147, v139
    v_fma_f32 v48, -v129, v144, v48
    v_fma_f32 v49, -v129, v145, v49
    v_fma_f32 v50, -v129, v146, v50
    v_fma_f32 v51, -v129, v147, v51
    v_fma_f32 v52, -v131, v144, v52
    v_fma_f32 v53, -v131, v145, v53
    v_fma_f32 v54, -v131, v146, v54
    v_fma_f32 v55, -v131, v147, v55
    s_cmp_ge_u32 s24, 36
    s_cbranch_scc1 qkva1_kv
    v_mul_f32 v152, 0x3eae1a93, v128
    v_mul_f32 v48, v152, v48
    v_mul_f32 v49, v152, v49
    v_mul_f32 v50, v152, v50
    v_mul_f32 v51, v152, v51
    v_cvt_pk_bf16_f32 v148, v48, v49
    v_cvt_pk_bf16_f32 v149, v50, v51
    v_add_u32 v153, 5242880, v8
    buffer_store_dwordx2 v[148:149], v153, s[20:23], 0 offen
    v_mul_f32 v152, 0x3eae1a93, v130
    v_mul_f32 v52, v152, v52
    v_mul_f32 v53, v152, v53
    v_mul_f32 v54, v152, v54
    v_mul_f32 v55, v152, v55
    v_cvt_pk_bf16_f32 v150, v52, v53
    v_cvt_pk_bf16_f32 v151, v54, v55
    v_add_u32 v153, 5242880, v9
    buffer_store_dwordx2 v[150:151], v153, s[20:23], 0 offen
    s_branch qkva1_fin
qkva1_kv:
    v_mul_f32 v48, v128, v48
    v_mul_f32 v49, v128, v49
    v_mul_f32 v50, v128, v50
    v_mul_f32 v51, v128, v51
    v_mul_f32 v52, v130, v52
    v_mul_f32 v53, v130, v53
    v_mul_f32 v54, v130, v54
    v_mul_f32 v55, v130, v55
    s_cmp_ge_u32 s24, 38
    s_cbranch_scc1 qkva1_vpart
    v_mov_b32 v158, 0
    v_mul_f32 v157, v48, v48
    v_fmac_f32 v157, v49, v49
    v_fmac_f32 v157, v50, v50
    v_fmac_f32 v157, v51, v51
    v_mov_b32 v156, v157
    s_nop 1
    v_permlane16_swap_b32 v157, v156
    v_add_f32 v157, v157, v156
    v_mov_b32 v156, v157
    s_nop 1
    v_permlane32_swap_b32 v157, v156
    v_add_f32 v157, v157, v156
    v_max_f32 v158, v158, v157
    v_mul_f32 v157, v52, v52
    v_fmac_f32 v157, v53, v53
    v_fmac_f32 v157, v54, v54
    v_fmac_f32 v157, v55, v55
    v_mov_b32 v156, v157
    s_nop 1
    v_permlane16_swap_b32 v157, v156
    v_add_f32 v157, v157, v156
    v_mov_b32 v156, v157
    s_nop 1
    v_permlane32_swap_b32 v157, v156
    v_add_f32 v157, v157, v156
    v_max_f32 v158, v158, v157
    s_nop 1
    v_max_f32_dpp v158, v158, v158 quad_perm:[1,0,3,2] row_mask:0xf bank_mask:0xf
    s_nop 1
    v_max_f32_dpp v158, v158, v158 quad_perm:[2,3,0,1] row_mask:0xf bank_mask:0xf
    s_nop 1
    v_max_f32_dpp v158, v158, v158 row_half_mirror row_mask:0xf bank_mask:0xf
    s_nop 1
    v_max_f32_dpp v158, v158, v158 row_mirror row_mask:0xf bank_mask:0xf
    s_sub_u32 s27, s24, 36
    s_lshl_b32 s27, s27, 8
    s_lshl_b32 s28, s12, 2
    s_add_u32 s27, s27, s28
    s_add_u32 s27, s27, 4734976
    v_mov_b32 v157, 0
    s_mov_b64 exec, 1
    buffer_store_dword v158, v157, s[20:23], s27 offen
    s_mov_b64 exec, -1
    s_mul_i32 s28, s12, 2496
    s_add_u32 s28, s28, 7864320
    s_cmp_eq_u32 s24, 37
    s_cbranch_scc1 qkva1_k1
    v_lshlrev_b32 v152, 4, v3
    v_lshrrev_b32 v153, 1, v4
    v_lshl_add_u32 v152, v153, 9, v152
    v_and_b32 v153, 1, v4
    v_lshl_add_u32 v152, v153, 3, v152
    v_cvt_pk_bf16_f32 v148, v48, v49
    v_cvt_pk_bf16_f32 v149, v50, v51
    buffer_store_dwordx2 v[148:149], v152, s[20:23], s28 offen offset:0
    v_cvt_pk_bf16_f32 v150, v52, v53
    v_cvt_pk_bf16_f32 v151, v54, v55
    buffer_store_dwordx2 v[150:151], v152, s[20:23], s28 offen offset:256
    s_branch qkva1_fin
qkva1_k1:
    v_lshlrev_b32 v152, 3, v3
    s_mov_b64 exec, 0xffff
    v_cvt_pk_bf16_f32 v148, v48, v49
    v_mov_b32 v149, 0x3f80
    buffer_store_dwordx2 v[148:149], v152, s[20:23], s28 offen offset:1024
    v_cvt_pk_bf16_f32 v150, v52, v53
    v_mov_b32 v151, 0x3f80
    buffer_store_dwordx2 v[150:151], v152, s[20:23], s28 offen offset:1152
    s_mov_b64 exec, -1
    s_branch qkva1_fin
qkva1_vpart:
    s_mul_i32 s28, s12, 2496
    s_add_u32 s28, s28, 7865600
    v_bfe_u32 v153, v3, 2, 1
    v_mul_u32_u24 v152, 304, v153
    v_and_b32 v153, 3, v3
    v_lshl_add_u32 v152, v153, 1, v152
    v_lshrrev_b32 v153, 3, v3
    v_lshl_add_u32 v152, v153, 3, v152
    s_cmp_eq_u32 s24, 39
    s_cbranch_scc1 qkva1_v1
    v_lshl_add_u32 v152, v4, 6, v152
    v_cvt_pk_bf16_f32 v132, v48, v48
    buffer_store_short v132, v152, s[20:23], s28 offen offset:0
    v_cvt_pk_bf16_f32 v133, v49, v49
    buffer_store_short v133, v152, s[20:23], s28 offen offset:16
    v_cvt_pk_bf16_f32 v134, v50, v50
    buffer_store_short v134, v152, s[20:23], s28 offen offset:32
    v_cvt_pk_bf16_f32 v135, v51, v51
    buffer_store_short v135, v152, s[20:23], s28 offen offset:48
    v_cvt_pk_bf16_f32 v132, v52, v52
    buffer_store_short v132, v152, s[20:23], s28 offen offset:608
    v_cvt_pk_bf16_f32 v133, v53, v53
    buffer_store_short v133, v152, s[20:23], s28 offen offset:624
    v_cvt_pk_bf16_f32 v134, v54, v54
    buffer_store_short v134, v152, s[20:23], s28 offen offset:640
    v_cvt_pk_bf16_f32 v135, v55, v55
    buffer_store_short v135, v152, s[20:23], s28 offen offset:656
    s_branch qkva1_fin
qkva1_v1:
    v_mov_b32 v134, 0x3f80
    s_mov_b64 exec, 0xffff
    v_cvt_pk_bf16_f32 v132, v48, v48
    v_cvt_pk_bf16_f32 v133, v49, v49
    buffer_store_short v132, v152, s[20:23], s28 offen offset:256
    buffer_store_short v133, v152, s[20:23], s28 offen offset:272
    buffer_store_short v134, v152, s[20:23], s28 offen offset:288
    v_cvt_pk_bf16_f32 v132, v52, v52
    v_cvt_pk_bf16_f32 v133, v53, v53
    buffer_store_short v132, v152, s[20:23], s28 offen offset:864
    buffer_store_short v133, v152, s[20:23], s28 offen offset:880
    buffer_store_short v134, v152, s[20:23], s28 offen offset:896
    s_mov_b64 exec, -1
qkva1_fin:
qkva1_end:
    s_endpgm
.globl oa1_kernel
.type oa1_kernel,@function
.p2align 8
oa1_kernel:
    s_cmp_ge_u32 s2, 256
    s_cbranch_scc1 oa1_end
    s_load_dwordx2 s[4:5], s[0:1], 80
    s_load_dwordx2 s[6:7], s[0:1], 80
    s_load_dwordx2 s[8:9], s[0:1], 80
    s_load_dwordx2 s[10:11], s[0:1], 80
    s_and_b32 s12, s2, 63
    s_lshr_b32 s13, s2, 6
    v_lshrrev_b32 v1, 6, v0
    v_and_b32 v2, 63, v0
    v_and_b32 v3, 15, v2
    v_readfirstlane_b32 s14, v1
    v_lshrrev_b32 v4, 4, v2
    v_mul_u32_u24 v5, 1152, v3
    v_lshl_add_u32 v5, v4, 4, v5
    v_lshlrev_b32 v6, 4, v2
    s_mul_i32 s15, s12, 36864
    s_lshl_b32 s26, s12, 5
    s_waitcnt lgkmcnt(0)
    s_add_u32 s16, s4, 8388608
    s_addc_u32 s17, s5, 0
    s_mov_b32 s18, 2359296
    s_mov_b32 s19, 0x00020000
    s_mov_b32 s20, s6
    s_mov_b32 s21, s7
    s_mov_b32 s22, 268435456
    s_mov_b32 s23, 0x00020000
    s_mov_b32 s40, s14
    s_mul_i32 s41, s40, 57
    s_lshr_b32 s41, s41, 10
    s_mul_i32 s42, s41, 18
    s_sub_u32 s42, s40, s42
    s_lshl_b32 s42, s42, 6
    s_mul_i32 s41, s41, 18432
    s_add_u32 s42, s42, s41
    s_add_u32 s42, s42, s15
    s_lshl_b32 s43, s40, 10
    s_mov_b32 m0, s43
    s_add_u32 s40, s40, 9
    buffer_load_dwordx4 v5, s[16:19], s42 offen lds
    s_mul_i32 s41, s40, 57
    s_lshr_b32 s41, s41, 10
    s_mul_i32 s42, s41, 18
    s_sub_u32 s42, s40, s42
    s_lshl_b32 s42, s42, 6
    s_mul_i32 s41, s41, 18432
    s_add_u32 s42, s42, s41
    s_add_u32 s42, s42, s15
    s_lshl_b32 s43, s40, 10
    s_mov_b32 m0, s43
    s_add_u32 s40, s40, 9
    buffer_load_dwordx4 v5, s[16:19], s42 offen lds
    s_mul_i32 s41, s40, 57
    s_lshr_b32 s41, s41, 10
    s_mul_i32 s42, s41, 18
    s_sub_u32 s42, s40, s42
    s_lshl_b32 s42, s42, 6
    s_mul_i32 s41, s41, 18432
    s_add_u32 s42, s42, s41
    s_add_u32 s42, s42, s15
    s_lshl_b32 s43, s40, 10
    s_mov_b32 m0, s43
    s_add_u32 s40, s40, 9
    buffer_load_dwordx4 v5, s[16:19], s42 offen lds
    s_mul_i32 s41, s40, 57
    s_lshr_b32 s41, s41, 10
    s_mul_i32 s42, s41, 18
    s_sub_u32 s42, s40, s42
    s_lshl_b32 s42, s42, 6
    s_mul_i32 s41, s41, 18432
    s_add_u32 s42, s42, s41
    s_add_u32 s42, s42, s15
    s_lshl_b32 s43, s40, 10
    s_mov_b32 m0, s43
    s_add_u32 s40, s40, 9
    buffer_load_dwordx4 v5, s[16:19], s42 offen lds
oa1_dmadone:
    s_barrier
    s_mul_i32 s24, s13, 9
    s_add_u32 s24, s24, s14
    s_mul_i32 s25, s24, 18432
    s_add_u32 s25, s25, 786432
    buffer_load_dwordx4 v[56:59], v6, s[20:23], s25 offen offset:0
    buffer_load_dwordx4 v[60:63], v6, s[20:23], s25 offen offset:1024
    buffer_load_dwordx4 v[64:67], v6, s[20:23], s25 offen offset:2048
    buffer_load_dwordx4 v[68:71], v6, s[20:23], s25 offen offset:3072
    s_add_u32 s25, s25, 4096
    buffer_load_dwordx4 v[72:75], v6, s[20:23], s25 offen offset:0
    buffer_load_dwordx4 v[76:79], v6, s[20:23], s25 offen offset:1024
    buffer_load_dwordx4 v[80:83], v6, s[20:23], s25 offen offset:2048
    buffer_load_dwordx4 v[84:87], v6, s[20:23], s25 offen offset:3072
    s_add_u32 s25, s25, 4096
    buffer_load_dwordx4 v[88:91], v6, s[20:23], s25 offen offset:0
    v_add_u32 v7, s26, v3
    s_lshl_b32 s27, s24, 4
    v_lshl_add_u32 v10, v4, 2, s27
    v_mul_u32_u24 v8, 1152, v7
    v_lshl_add_u32 v8, v10, 1, v8
    v_add_u32 v9, 18432, v8
    s_add_u32 s28, s8, 14680064
    s_addc_u32 s29, s9, 0
    s_mov_b32 s30, 2359296
    s_mov_b32 s31, 0x00020000
    s_add_u32 s32, s10, 17825792
    s_addc_u32 s33, s11, 0
    s_mov_b32 s34, 2359296
    s_mov_b32 s35, 0x00020000
    buffer_load_dwordx2 v[148:149], v8, s[28:31], 0 offen
    buffer_load_dwordx2 v[150:151], v9, s[28:31], 0 offen
    s_waitcnt vmcnt(11)
    s_barrier
    v_mov_b32 v48, 0
    v_mov_b32 v49, 0
    v_mov_b32 v50, 0
    v_mov_b32 v51, 0
    v_mov_b32 v52, 0
    v_mov_b32 v53, 0
    v_mov_b32 v54, 0
    v_mov_b32 v55, 0
    ds_read_b128 v[16:19], v6 offset:0
    ds_read_b128 v[20:23], v6 offset:18432
    ds_read_b128 v[24:27], v6 offset:1024
    ds_read_b128 v[28:31], v6 offset:19456
    ds_read_b128 v[32:35], v6 offset:2048
    ds_read_b128 v[36:39], v6 offset:20480
    ds_read_b128 v[40:43], v6 offset:3072
    ds_read_b128 v[44:47], v6 offset:21504
    buffer_load_dwordx4 v[92:95], v6, s[20:23], s25 offen offset:1024
    s_waitcnt vmcnt(11) lgkmcnt(6)
    v_mfma_f32_16x16x32_bf16 v[48:51], v[56:59], v[16:19], v[48:51]
    v_mfma_f32_16x16x32_bf16 v[52:55], v[56:59], v[20:23], v[52:55]
    ds_read_b128 v[16:19], v6 offset:4096
    ds_read_b128 v[20:23], v6 offset:22528
    buffer_load_dwordx4 v[96:99], v6, s[20:23], s25 offen offset:2048
    s_waitcnt vmcnt(11) lgkmcnt(6)
    v_mfma_f32_16x16x32_bf16 v[48:51], v[60:63], v[24:27], v[48:51]
    v_mfma_f32_16x16x32_bf16 v[52:55], v[60:63], v[28:31], v[52:55]
    ds_read_b128 v[24:27], v6 offset:5120
    ds_read_b128 v[28:31], v6 offset:23552
    buffer_load_dwordx4 v[100:103], v6, s[20:23], s25 offen offset:3072
    s_waitcnt vmcnt(11) lgkmcnt(6)
    v_mfma_f32_16x16x32_bf16 v[48:51], v[64:67], v[32:35], v[48:51]
    v_mfma_f32_16x16x32_bf16 v[52:55], v[64:67], v[36:39], v[52:55]
    ds_read_b128 v[32:35], v6 offset:6144
    ds_read_b128 v[36:39], v6 offset:24576
    s_add_u32 s25, s25, 4096
    buffer_load_dwordx4 v[104:107], v6, s[20:23], s25 offen offset:0
    s_waitcnt vmcnt(11) lgkmcnt(6)
    v_mfma_f32_16x16x32_bf16 v[48:51], v[68:71], v[40:43], v[48:51]
    v_mfma_f32_16x16x32_bf16 v[52:55], v[68:71], v[44:47], v[52:55]
    ds_read_b128 v[40:43], v6 offset:7168
    ds_read_b128 v[44:47], v6 offset:25600
    buffer_load_dwordx4 v[108:111], v6, s[20:23], s25 offen offset:1024
    s_waitcnt vmcnt(11) lgkmcnt(6)
    v_mfma_f32_16x16x32_bf16 v[48:51], v[72:75], v[16:19], v[48:51]
    v_mfma_f32_16x16x32_bf16 v[52:55], v[72:75], v[20:23], v[52:55]
    ds_read_b128 v[16:19], v6 offset:8192
    ds_read_b128 v[20:23], v6 offset:26624
    buffer_load_dwordx4 v[112:115], v6, s[20:23], s25 offen offset:2048
    s_waitcnt vmcnt(11) lgkmcnt(6)
    v_mfma_f32_16x16x32_bf16 v[48:51], v[76:79], v[24:27], v[48:51]
    v_mfma_f32_16x16x32_bf16 v[52:55], v[76:79], v[28:31], v[52:55]
    ds_read_b128 v[24:27], v6 offset:9216
    ds_read_b128 v[28:31], v6 offset:27648
    buffer_load_dwordx4 v[116:119], v6, s[20:23], s25 offen offset:3072
    s_waitcnt vmcnt(11) lgkmcnt(6)
    v_mfma_f32_16x16x32_bf16 v[48:51], v[80:83], v[32:35], v[48:51]
    v_mfma_f32_16x16x32_bf16 v[52:55], v[80:83], v[36:39], v[52:55]
    ds_read_b128 v[32:35], v6 offset:10240
    ds_read_b128 v[36:39], v6 offset:28672
    s_add_u32 s25, s25, 4096
    buffer_load_dwordx4 v[120:123], v6, s[20:23], s25 offen offset:0
    s_waitcnt vmcnt(11) lgkmcnt(6)
    v_mfma_f32_16x16x32_bf16 v[48:51], v[84:87], v[40:43], v[48:51]
    v_mfma_f32_16x16x32_bf16 v[52:55], v[84:87], v[44:47], v[52:55]
    ds_read_b128 v[40:43], v6 offset:11264
    ds_read_b128 v[44:47], v6 offset:29696
    buffer_load_dwordx4 v[124:127], v6, s[20:23], s25 offen offset:1024
    s_waitcnt vmcnt(11) lgkmcnt(6)
    v_mfma_f32_16x16x32_bf16 v[48:51], v[88:91], v[16:19], v[48:51]
    v_mfma_f32_16x16x32_bf16 v[52:55], v[88:91], v[20:23], v[52:55]
    ds_read_b128 v[16:19], v6 offset:12288
    ds_read_b128 v[20:23], v6 offset:30720
    s_waitcnt vmcnt(8) lgkmcnt(6)
    v_mfma_f32_16x16x32_bf16 v[48:51], v[92:95], v[24:27], v[48:51]
    v_mfma_f32_16x16x32_bf16 v[52:55], v[92:95], v[28:31], v[52:55]
    ds_read_b128 v[24:27], v6 offset:13312
    ds_read_b128 v[28:31], v6 offset:31744
    s_waitcnt vmcnt(7) lgkmcnt(6)
    v_mfma_f32_16x16x32_bf16 v[48:51], v[96:99], v[32:35], v[48:51]
    v_mfma_f32_16x16x32_bf16 v[52:55], v[96:99], v[36:39], v[52:55]
    ds_read_b128 v[32:35], v6 offset:14336
    ds_read_b128 v[36:39], v6 offset:32768
    s_waitcnt vmcnt(6) lgkmcnt(6)
    v_mfma_f32_16x16x32_bf16 v[48:51], v[100:103], v[40:43], v[48:51]
    v_mfma_f32_16x16x32_bf16 v[52:55], v[100:103], v[44:47], v[52:55]
    ds_read_b128 v[40:43], v6 offset:15360
    ds_read_b128 v[44:47], v6 offset:33792
    s_waitcnt vmcnt(5) lgkmcnt(6)
    v_mfma_f32_16x16x32_bf16 v[48:51], v[104:107], v[16:19], v[48:51]
    v_mfma_f32_16x16x32_bf16 v[52:55], v[104:107], v[20:23], v[52:55]
    ds_read_b128 v[16:19], v6 offset:16384
    ds_read_b128 v[20:23], v6 offset:34816
    s_waitcnt vmcnt(4) lgkmcnt(6)
    v_mfma_f32_16x16x32_bf16 v[48:51], v[108:111], v[24:27], v[48:51]
    v_mfma_f32_16x16x32_bf16 v[52:55], v[108:111], v[28:31], v[52:55]
    ds_read_b128 v[24:27], v6 offset:17408
    ds_read_b128 v[28:31], v6 offset:35840
    s_waitcnt vmcnt(3) lgkmcnt(6)
    v_mfma_f32_16x16x32_bf16 v[48:51], v[112:115], v[32:35], v[48:51]
    v_mfma_f32_16x16x32_bf16 v[52:55], v[112:115], v[36:39], v[52:55]
    s_waitcnt vmcnt(2) lgkmcnt(4)
    v_mfma_f32_16x16x32_bf16 v[48:51], v[116:119], v[40:43], v[48:51]
    v_mfma_f32_16x16x32_bf16 v[52:55], v[116:119], v[44:47], v[52:55]
    s_waitcnt vmcnt(1) lgkmcnt(2)
    v_mfma_f32_16x16x32_bf16 v[48:51], v[120:123], v[16:19], v[48:51]
    v_mfma_f32_16x16x32_bf16 v[52:55], v[120:123], v[20:23], v[52:55]
    s_waitcnt vmcnt(0) lgkmcnt(0)
    v_mfma_f32_16x16x32_bf16 v[48:51], v[124:127], v[24:27], v[48:51]
    v_mfma_f32_16x16x32_bf16 v[52:55], v[124:127], v[28:31], v[52:55]
    s_waitcnt vmcnt(0)
    s_nop 7
    v_mov_b32 v159, 0x3f803f80
    v_cvt_pk_bf16_f32 v152, v48, v49
    v_cvt_pk_bf16_f32 v153, v50, v51
    v_lshlrev_b32 v154, 16, v152
    v_and_b32 v155, 0xffff0000, v152
    v_lshlrev_b32 v156, 16, v153
    v_and_b32 v157, 0xffff0000, v153
    v_lshlrev_b32 v158, 16, v148
    v_and_b32 v152, 0xffff0000, v148
    v_add_f32 v154, v154, v158
    v_add_f32 v155, v155, v152
    v_lshlrev_b32 v158, 16, v149
    v_and_b32 v152, 0xffff0000, v149
    v_add_f32 v156, v156, v158
    v_add_f32 v157, v157, v152
    v_cvt_pk_bf16_f32 v148, v154, v155
    v_cvt_pk_bf16_f32 v149, v156, v157
    buffer_store_dwordx2 v[148:149], v8, s[32:35], 0 offen
    v_dot2_f32_bf16 v128, v148, v159, 0
    v_dot2_f32_bf16 v129, v148, v148, 0
    v_dot2_f32_bf16 v128, v149, v159, v128
    v_dot2_f32_bf16 v129, v149, v149, v129
    v_cvt_pk_bf16_f32 v152, v52, v53
    v_cvt_pk_bf16_f32 v153, v54, v55
    v_lshlrev_b32 v154, 16, v152
    v_and_b32 v155, 0xffff0000, v152
    v_lshlrev_b32 v156, 16, v153
    v_and_b32 v157, 0xffff0000, v153
    v_lshlrev_b32 v158, 16, v150
    v_and_b32 v152, 0xffff0000, v150
    v_add_f32 v154, v154, v158
    v_add_f32 v155, v155, v152
    v_lshlrev_b32 v158, 16, v151
    v_and_b32 v152, 0xffff0000, v151
    v_add_f32 v156, v156, v158
    v_add_f32 v157, v157, v152
    v_cvt_pk_bf16_f32 v150, v154, v155
    v_cvt_pk_bf16_f32 v151, v156, v157
    buffer_store_dwordx2 v[150:151], v9, s[32:35], 0 offen
    v_dot2_f32_bf16 v130, v150, v159, 0
    v_dot2_f32_bf16 v131, v150, v150, 0
    v_dot2_f32_bf16 v130, v151, v159, v130
    v_dot2_f32_bf16 v131, v151, v151, v131
    s_nop 2
    v_mov_b32 v152, v128
    s_nop 1
    v_permlane16_swap_b32 v128, v152
    v_add_f32 v128, v128, v152
    v_mov_b32 v152, v128
    s_nop 1
    v_permlane32_swap_b32 v128, v152
    v_add_f32 v128, v128, v152
    v_mov_b32 v152, v129
    s_nop 1
    v_permlane16_swap_b32 v129, v152
    v_add_f32 v129, v129, v152
    v_mov_b32 v152, v129
    s_nop 1
    v_permlane32_swap_b32 v129, v152
    v_add_f32 v129, v129, v152
    v_mov_b32 v152, v130
    s_nop 1
    v_permlane16_swap_b32 v130, v152
    v_add_f32 v130, v130, v152
    v_mov_b32 v152, v130
    s_nop 1
    v_permlane32_swap_b32 v130, v152
    v_add_f32 v130, v130, v152
    v_mov_b32 v152, v131
    s_nop 1
    v_permlane16_swap_b32 v131, v152
    v_add_f32 v131, v131, v152
    v_mov_b32 v152, v131
    s_nop 1
    v_permlane32_swap_b32 v131, v152
    v_add_f32 v131, v131, v152
    s_lshl_b32 s27, s14, 8
    v_lshl_add_u32 v11, v3, 3, s27
    s_mov_b64 exec, 0xffff
    ds_write_b64 v11, v[128:129] offset:36864
    ds_write_b64 v11, v[130:131] offset:36992
    s_mov_b64 exec, -1
    s_waitcnt lgkmcnt(0)
    s_barrier
    s_cmp_lg_u32 s14, 0
    s_cbranch_scc1 oa1_fin
    v_lshlrev_b32 v11, 3, v2
    ds_read_b64 v[56:57], v11 offset:36864
    ds_read_b64 v[58:59], v11 offset:37120
    ds_read_b64 v[60:61], v11 offset:37376
    ds_read_b64 v[62:63], v11 offset:37632
    ds_read_b64 v[64:65], v11 offset:37888
    ds_read_b64 v[66:67], v11 offset:38144
    ds_read_b64 v[68:69], v11 offset:38400
    ds_read_b64 v[70:71], v11 offset:38656
    ds_read_b64 v[72:73], v11 offset:38912
    s_waitcnt lgkmcnt(0)
    v_add_f32 v56, v56, v58
    v_add_f32 v57, v57, v59
    v_add_f32 v56, v56, v60
    v_add_f32 v57, v57, v61
    v_add_f32 v56, v56, v62
    v_add_f32 v57, v57, v63
    v_add_f32 v56, v56, v64
    v_add_f32 v57, v57, v65
    v_add_f32 v56, v56, v66
    v_add_f32 v57, v57, v67
    v_add_f32 v56, v56, v68
    v_add_f32 v57, v57, v69
    v_add_f32 v56, v56, v70
    v_add_f32 v57, v57, v71
    v_add_f32 v56, v56, v72
    v_add_f32 v57, v57, v73
    v_add_u32 v11, s26, v2
    v_lshlrev_b32 v11, 5, v11
    s_lshl_b32 s27, s13, 3
    s_add_u32 s27, s27, 4980736
    s_mov_b32 exec_lo, -1
    s_mov_b32 exec_hi, 0
    buffer_store_dwordx2 v[56:57], v11, s[20:23], s27 offen
    s_mov_b64 exec, -1
oa1_fin:
oa1_end:
    s_endpgm
.globl qkvb1_kernel
.type qkvb1_kernel,@function
.p2align 8
qkvb1_kernel:
    s_cmp_ge_u32 s2, 256
    s_cbranch_scc1 qkvb1_end
    s_load_dwordx2 s[4:5], s[0:1], 80
    s_load_dwordx2 s[6:7], s[0:1], 80
    s_and_b32 s12, s2, 31
    s_lshr_b32 s13, s2, 5
    v_lshrrev_b32 v1, 6, v0
    v_and_b32 v2, 63, v0
    v_and_b32 v7, 15, v2
    v_readfirstlane_b32 s14, v1
    v_lshrrev_b32 v3, 2, v2
    v_and_b32 v4, 3, v2
    v_lshrrev_b32 v8, 4, v2
    v_lshlrev_b32 v6, 4, v2
    s_lshl_b32 s26, s12, 6
    s_sub_u32 s26, s26, 16
    s_waitcnt lgkmcnt(0)
    s_add_u32 s16, s4, 17825792
    s_addc_u32 s17, s5, 0
    s_mov_b32 s18, 2359296
    s_mov_b32 s19, 0x00020000
    s_mov_b32 s20, s6
    s_mov_b32 s21, s7
    s_mov_b32 s22, 268435456
    s_mov_b32 s23, 0x00020000
    s_cmp_ge_u32 s14, 2
    s_cbranch_scc1 qkvb1_nost
    v_min_u32 v11, 79, v0
    v_add_u32 v11, s26, v11
    v_max_i32 v11, 0, v11
    v_lshlrev_b32 v11, 5, v11
    v_add_u32 v11, 4980736, v11
    buffer_load_dwordx4 v[56:59], v11, s[20:23], 0 offen
    buffer_load_dwordx4 v[60:63], v11, s[20:23], 0 offen offset:16
qkvb1_nost:
    v_mul_u32_u24 v5, 1152, v7
    v_lshl_add_u32 v5, v8, 4, v5
    s_mov_b32 s40, s14
    s_mul_i32 s41, s40, 205
    s_lshr_b32 s41, s41, 10
    s_mul_i32 s42, s41, 5
    s_sub_u32 s42, s40, s42
    s_lshl_b32 s43, s42, 4
    s_add_i32 s43, s43, s26
    s_max_i32 s43, s43, 0
    s_mul_i32 s43, s43, 1152
    s_lshl_b32 s44, s41, 6
    s_add_u32 s43, s43, s44
    s_mul_i32 s42, s42, 18
    s_add_u32 s42, s42, s41
    s_lshl_b32 s42, s42, 10
    s_mov_b32 m0, s42
    s_add_u32 s40, s40, 8
    buffer_load_dwordx4 v5, s[16:19], s43 offen lds
    s_mul_i32 s41, s40, 205
    s_lshr_b32 s41, s41, 10
    s_mul_i32 s42, s41, 5
    s_sub_u32 s42, s40, s42
    s_lshl_b32 s43, s42, 4
    s_add_i32 s43, s43, s26
    s_max_i32 s43, s43, 0
    s_mul_i32 s43, s43, 1152
    s_lshl_b32 s44, s41, 6
    s_add_u32 s43, s43, s44
    s_mul_i32 s42, s42, 18
    s_add_u32 s42, s42, s41
    s_lshl_b32 s42, s42, 10
    s_mov_b32 m0, s42
    s_add_u32 s40, s40, 8
    buffer_load_dwordx4 v5, s[16:19], s43 offen lds
    s_mul_i32 s41, s40, 205
    s_lshr_b32 s41, s41, 10
    s_mul_i32 s42, s41, 5
    s_sub_u32 s42, s40, s42
    s_lshl_b32 s43, s42, 4
    s_add_i32 s43, s43, s26
    s_max_i32 s43, s43, 0
    s_mul_i32 s43, s43, 1152
    s_lshl_b32 s44, s41, 6
    s_add_u32 s43, s43, s44
    s_mul_i32 s42, s42, 18
    s_add_u32 s42, s42, s41
    s_lshl_b32 s42, s42, 10
    s_mov_b32 m0, s42
    s_add_u32 s40, s40, 8
    buffer_load_dwordx4 v5, s[16:19], s43 offen lds
    s_mul_i32 s41, s40, 205
    s_lshr_b32 s41, s41, 10
    s_mul_i32 s42, s41, 5
    s_sub_u32 s42, s40, s42
    s_lshl_b32 s43, s42, 4
    s_add_i32 s43, s43, s26
    s_max_i32 s43, s43, 0
    s_mul_i32 s43, s43, 1152
    s_lshl_b32 s44, s41, 6
    s_add_u32 s43, s43, s44
    s_mul_i32 s42, s42, 18
    s_add_u32 s42, s42, s41
    s_lshl_b32 s42, s42, 10
    s_mov_b32 m0, s42
    s_add_u32 s40, s40, 8
    buffer_load_dwordx4 v5, s[16:19], s43 offen lds
    s_mul_i32 s24, s13, 15
    s_lshl_b32 s25, s14, 1
    s_add_u32 s27, s24, s25
    s_mul_i32 s24, s27, 18432
    s_add_u32 s24, s24, 2359296
    s_add_u32 s25, s24, 18432
    buffer_load_dwordx4 v[96:99], v6, s[20:23], s24 offen offset:0
    buffer_load_dwordx4 v[168:171], v6, s[20:23], s25 offen offset:0
    buffer_load_dwordx4 v[100:103], v6, s[20:23], s24 offen offset:1024
    buffer_load_dwordx4 v[172:175], v6, s[20:23], s25 offen offset:1024
    buffer_load_dwordx4 v[104:107], v6, s[20:23], s24 offen offset:2048
    buffer_load_dwordx4 v[176:179], v6, s[20:23], s25 offen offset:2048
    buffer_load_dwordx4 v[108:111], v6, s[20:23], s24 offen offset:3072
    buffer_load_dwordx4 v[180:183], v6, s[20:23], s25 offen offset:3072
    s_mul_i32 s41, s40, 205
    s_lshr_b32 s41, s41, 10
    s_mul_i32 s42, s41, 5
    s_sub_u32 s42, s40, s42
    s_lshl_b32 s43, s42, 4
    s_add_i32 s43, s43, s26
    s_max_i32 s43, s43, 0
    s_mul_i32 s43, s43, 1152
    s_lshl_b32 s44, s41, 6
    s_add_u32 s43, s43, s44
    s_mul_i32 s42, s42, 18
    s_add_u32 s42, s42, s41
    s_lshl_b32 s42, s42, 10
    s_mov_b32 m0, s42
    s_add_u32 s40, s40, 8
    buffer_load_dwordx4 v5, s[16:19], s43 offen lds
    s_mul_i32 s41, s40, 205
    s_lshr_b32 s41, s41, 10
    s_mul_i32 s42, s41, 5
    s_sub_u32 s42, s40, s42
    s_lshl_b32 s43, s42, 4
    s_add_i32 s43, s43, s26
    s_max_i32 s43, s43, 0
    s_mul_i32 s43, s43, 1152
    s_lshl_b32 s44, s41, 6
    s_add_u32 s43, s43, s44
    s_mul_i32 s42, s42, 18
    s_add_u32 s42, s42, s41
    s_lshl_b32 s42, s42, 10
    s_mov_b32 m0, s42
    s_add_u32 s40, s40, 8
    buffer_load_dwordx4 v5, s[16:19], s43 offen lds
    s_mul_i32 s41, s40, 205
    s_lshr_b32 s41, s41, 10
    s_mul_i32 s42, s41, 5
    s_sub_u32 s42, s40, s42
    s_lshl_b32 s43, s42, 4
    s_add_i32 s43, s43, s26
    s_max_i32 s43, s43, 0
    s_mul_i32 s43, s43, 1152
    s_lshl_b32 s44, s41, 6
    s_add_u32 s43, s43, s44
    s_mul_i32 s42, s42, 18
    s_add_u32 s42, s42, s41
    s_lshl_b32 s42, s42, 10
    s_mov_b32 m0, s42
    s_add_u32 s40, s40, 8
    buffer_load_dwordx4 v5, s[16:19], s43 offen lds
    s_mul_i32 s41, s40, 205
    s_lshr_b32 s41, s41, 10
    s_mul_i32 s42, s41, 5
    s_sub_u32 s42, s40, s42
    s_lshl_b32 s43, s42, 4
    s_add_i32 s43, s43, s26
    s_max_i32 s43, s43, 0
    s_mul_i32 s43, s43, 1152
    s_lshl_b32 s44, s41, 6
    s_add_u32 s43, s43, s44
    s_mul_i32 s42, s42, 18
    s_add_u32 s42, s42, s41
    s_lshl_b32 s42, s42, 10
    s_mov_b32 m0, s42
    s_add_u32 s40, s40, 8
    buffer_load_dwordx4 v5, s[16:19], s43 offen lds
    s_lshl_b32 s27, s27, 6
    s_add_u32 s27, s27, 4657152
    v_lshlrev_b32 v12, 4, v8
    buffer_load_dwordx4 v[240:243], v12, s[20:23], s27 offen
    buffer_load_dwordx4 v[244:247], v12, s[20:23], s27 offen offset:64
    s_add_u32 s28, s27, 16384
    s_add_u32 s29, s27, 32768
    s_waitcnt vmcnt(14)
    s_cmp_ge_u32 s14, 2
    s_cbranch_scc1 qkvb1_nost2
    v_add_f32 v56, v56, v58
    v_add_f32 v57, v57, v59
    v_add_f32 v60, v60, v62
    v_add_f32 v61, v61, v63
    v_add_f32 v56, v56, v60
    v_add_f32 v57, v57, v61
    v_mul_f32 v56, 0x3ae38e39, v56
    v_mul_f32 v57, 0x3ae38e39, v57
    v_fma_f32 v57, -v56, v56, v57
    v_max_f32 v57, 0, v57
    v_cvt_pk_bf16_f32 v248, v56, v57
    v_and_b32 v58, 0xffff0000, v248
    v_lshlrev_b32 v57, 16, v248
    v_add_f32 v58, 0x3727c5ac, v58
    v_cvt_pk_bf16_f32 v248, v58, v58
    v_lshlrev_b32 v58, 16, v248
    v_sqrt_f32 v58, v58
    s_nop 0
    v_cvt_pk_bf16_f32 v248, v58, v58
    v_lshlrev_b32 v58, 16, v248
    v_rcp_f32 v56, v58
    s_nop 0
    v_lshlrev_b32 v11, 3, v0
    v_add_u32 v11, 92160, v11
    ds_write_b64 v11, v[56:57]
    s_waitcnt lgkmcnt(0)
qkvb1_nost2:
    s_barrier
    v_mov_b32 v56, 0
    v_mov_b32 v57, 0
    v_mov_b32 v58, 0
    v_mov_b32 v59, 0
    v_mov_b32 v60, 0
    v_mov_b32 v61, 0
    v_mov_b32 v62, 0
    v_mov_b32 v63, 0
    v_mov_b32 v64, 0
    v_mov_b32 v65, 0
    v_mov_b32 v66, 0
    v_mov_b32 v67, 0
    v_mov_b32 v68, 0
    v_mov_b32 v69, 0
    v_mov_b32 v70, 0
    v_mov_b32 v71, 0
    v_mov_b32 v72, 0
    v_mov_b32 v73, 0
    v_mov_b32 v74, 0
    v_mov_b32 v75, 0
    v_mov_b32 v76, 0
    v_mov_b32 v77, 0
    v_mov_b32 v78, 0
    v_mov_b32 v79, 0
    v_mov_b32 v80, 0
    v_mov_b32 v81, 0
    v_mov_b32 v82, 0
    v_mov_b32 v83, 0
    v_mov_b32 v84, 0
    v_mov_b32 v85, 0
    v_mov_b32 v86, 0
    v_mov_b32 v87, 0
    v_mov_b32 v88, 0
    v_mov_b32 v89, 0
    v_mov_b32 v90, 0
    v_mov_b32 v91, 0
    v_mov_b32 v92, 0
    v_mov_b32 v93, 0
    v_mov_b32 v94, 0
    v_mov_b32 v95, 0
    v_add_u32 v15, 55296, v6
    ds_read_b128 v[16:19], v6 offset:0
    ds_read_b128 v[20:23], v6 offset:18432
    ds_read_b128 v[24:27], v6 offset:36864
    ds_read_b128 v[28:31], v15 offset:0
    ds_read_b128 v[32:35], v15 offset:18432
    ds_read_b128 v[36:39], v6 offset:1024
    ds_read_b128 v[40:43], v6 offset:19456
    ds_read_b128 v[44:47], v6 offset:37888
    ds_read_b128 v[48:51], v15 offset:1024
    ds_read_b128 v[52:55], v15 offset:19456
    s_add_u32 s24, s24, 4096
    buffer_load_dwordx4 v[112:115], v6, s[20:23], s24 offen offset:0
    s_add_u32 s25, s25, 4096
    buffer_load_dwordx4 v[184:187], v6, s[20:23], s25 offen offset:0
    s_waitcnt vmcnt(14) lgkmcnt(5)
    v_mfma_f32_16x16x32_bf16 v[56:59], v[96:99], v[16:19], v[56:59]
    v_mfma_f32_16x16x32_bf16 v[60:63], v[168:171], v[16:19], v[60:63]
    v_mfma_f32_16x16x32_bf16 v[64:67], v[96:99], v[20:23], v[64:67]
    v_mfma_f32_16x16x32_bf16 v[68:71], v[168:171], v[20:23], v[68:71]
    v_mfma_f32_16x16x32_bf16 v[72:75], v[96:99], v[24:27], v[72:75]
    v_mfma_f32_16x16x32_bf16 v[76:79], v[168:171], v[24:27], v[76:79]
    v_mfma_f32_16x16x32_bf16 v[80:83], v[96:99], v[28:31], v[80:83]
    v_mfma_f32_16x16x32_bf16 v[84:87], v[168:171], v[28:31], v[84:87]
    v_mfma_f32_16x16x32_bf16 v[88:91], v[96:99], v[32:35], v[88:91]
    v_mfma_f32_16x16x32_bf16 v[92:95], v[168:171], v[32:35], v[92:95]
    ds_read_b128 v[16:19], v6 offset:2048
    ds_read_b128 v[20:23], v6 offset:20480
    ds_read_b128 v[24:27], v6 offset:38912
    ds_read_b128 v[28:31], v15 offset:2048
    ds_read_b128 v[32:35], v15 offset:20480
    s_mul_i32 s41, s40, 205
    s_lshr_b32 s41, s41, 10
    s_mul_i32 s42, s41, 5
    s_sub_u32 s42, s40, s42
    s_lshl_b32 s43, s42, 4
    s_add_i32 s43, s43, s26
    s_max_i32 s43, s43, 0
    s_mul_i32 s43, s43, 1152
    s_lshl_b32 s44, s41, 6
    s_add_u32 s43, s43, s44
    s_mul_i32 s42, s42, 18
    s_add_u32 s42, s42, s41
    s_lshl_b32 s42, s42, 10
    s_mov_b32 m0, s42
    s_add_u32 s40, s40, 8
    buffer_load_dwordx4 v5, s[16:19], s43 offen lds
    s_mul_i32 s41, s40, 205
    s_lshr_b32 s41, s41, 10
    s_mul_i32 s42, s41, 5
    s_sub_u32 s42, s40, s42
    s_lshl_b32 s43, s42, 4
    s_add_i32 s43, s43, s26
    s_max_i32 s43, s43, 0
    s_mul_i32 s43, s43, 1152
    s_lshl_b32 s44, s41, 6
    s_add_u32 s43, s43, s44
    s_mul_i32 s42, s42, 18
    s_add_u32 s42, s42, s41
    s_lshl_b32 s42, s42, 10
    s_mov_b32 m0, s42
    s_add_u32 s40, s40, 8
    buffer_load_dwordx4 v5, s[16:19], s43 offen lds
    s_mul_i32 s41, s40, 205
    s_lshr_b32 s41, s41, 10
    s_mul_i32 s42, s41, 5
    s_sub_u32 s42, s40, s42
    s_lshl_b32 s43, s42, 4
    s_add_i32 s43, s43, s26
    s_max_i32 s43, s43, 0
    s_mul_i32 s43, s43, 1152
    s_lshl_b32 s44, s41, 6
    s_add_u32 s43, s43, s44
    s_mul_i32 s42, s42, 18
    s_add_u32 s42, s42, s41
    s_lshl_b32 s42, s42, 10
    s_mov_b32 m0, s42
    s_add_u32 s40, s40, 8
    buffer_load_dwordx4 v5, s[16:19], s43 offen lds
    s_cmp_ge_u32 s40, 90
    s_cbranch_scc1 qkvb1_dmadone
    s_mul_i32 s41, s40, 205
    s_lshr_b32 s41, s41, 10
    s_mul_i32 s42, s41, 5
    s_sub_u32 s42, s40, s42
    s_lshl_b32 s43, s42, 4
    s_add_i32 s43, s43, s26
    s_max_i32 s43, s43, 0
    s_mul_i32 s43, s43, 1152
    s_lshl_b32 s44, s41, 6
    s_add_u32 s43, s43, s44
    s_mul_i32 s42, s42, 18
    s_add_u32 s42, s42, s41
    s_lshl_b32 s42, s42, 10
    s_mov_b32 m0, s42
    s_add_u32 s40, s40, 8
    buffer_load_dwordx4 v5, s[16:19], s43 offen lds
qkvb1_dmadone:
    buffer_load_dwordx4 v[116:119], v6, s[20:23], s24 offen offset:1024
    buffer_load_dwordx4 v[188:191], v6, s[20:23], s25 offen offset:1024
    s_waitcnt vmcnt(17) lgkmcnt(5)
    v_mfma_f32_16x16x32_bf16 v[56:59], v[100:103], v[36:39], v[56:59]
    v_mfma_f32_16x16x32_bf16 v[60:63], v[172:175], v[36:39], v[60:63]
    v_mfma_f32_16x16x32_bf16 v[64:67], v[100:103], v[40:43], v[64:67]
    v_mfma_f32_16x16x32_bf16 v[68:71], v[172:175], v[40:43], v[68:71]
    v_mfma_f32_16x16x32_bf16 v[72:75], v[100:103], v[44:47], v[72:75]
    v_mfma_f32_16x16x32_bf16 v[76:79], v[172:175], v[44:47], v[76:79]
    v_mfma_f32_16x16x32_bf16 v[80:83], v[100:103], v[48:51], v[80:83]
    v_mfma_f32_16x16x32_bf16 v[84:87], v[172:175], v[48:51], v[84:87]
    v_mfma_f32_16x16x32_bf16 v[88:91], v[100:103], v[52:55], v[88:91]
    v_mfma_f32_16x16x32_bf16 v[92:95], v[172:175], v[52:55], v[92:95]
    ds_read_b128 v[36:39], v6 offset:3072
    ds_read_b128 v[40:43], v6 offset:21504
    ds_read_b128 v[44:47], v6 offset:39936
    ds_read_b128 v[48:51], v15 offset:3072
    ds_read_b128 v[52:55], v15 offset:21504
    buffer_load_dwordx4 v[120:123], v6, s[20:23], s24 offen offset:2048
    buffer_load_dwordx4 v[192:195], v6, s[20:23], s25 offen offset:2048
    s_waitcnt vmcnt(17) lgkmcnt(5)
    v_mfma_f32_16x16x32_bf16 v[56:59], v[104:107], v[16:19], v[56:59]
    v_mfma_f32_16x16x32_bf16 v[60:63], v[176:179], v[16:19], v[60:63]
    v_mfma_f32_16x16x32_bf16 v[64:67], v[104:107], v[20:23], v[64:67]
    v_mfma_f32_16x16x32_bf16 v[68:71], v[176:179], v[20:23], v[68:71]
    v_mfma_f32_16x16x32_bf16 v[72:75], v[104:107], v[24:27], v[72:75]
    v_mfma_f32_16x16x32_bf16 v[76:79], v[176:179], v[24:27], v[76:79]
    v_mfma_f32_16x16x32_bf16 v[80:83], v[104:107], v[28:31], v[80:83]
    v_mfma_f32_16x16x32_bf16 v[84:87], v[176:179], v[28:31], v[84:87]
    v_mfma_f32_16x16x32_bf16 v[88:91], v[104:107], v[32:35], v[88:91]
    v_mfma_f32_16x16x32_bf16 v[92:95], v[176:179], v[32:35], v[92:95]
    ds_read_b128 v[16:19], v6 offset:4096
    ds_read_b128 v[20:23], v6 offset:22528
    ds_read_b128 v[24:27], v6 offset:40960
    ds_read_b128 v[28:31], v15 offset:4096
    ds_read_b128 v[32:35], v15 offset:22528
    buffer_load_dwordx4 v[248:251], v12, s[20:23], s28 offen
    buffer_load_dwordx4 v[252:255], v12, s[20:23], s28 offen offset:64
    buffer_load_dwordx4 v[124:127], v6, s[20:23], s24 offen offset:3072
    buffer_load_dwordx4 v[196:199], v6, s[20:23], s25 offen offset:3072
    s_waitcnt vmcnt(19) lgkmcnt(5)
    v_mfma_f32_16x16x32_bf16 v[56:59], v[108:111], v[36:39], v[56:59]
    v_mfma_f32_16x16x32_bf16 v[60:63], v[180:183], v[36:39], v[60:63]
    v_mfma_f32_16x16x32_bf16 v[64:67], v[108:111], v[40:43], v[64:67]
    v_mfma_f32_16x16x32_bf16 v[68:71], v[180:183], v[40:43], v[68:71]
    v_mfma_f32_16x16x32_bf16 v[72:75], v[108:111], v[44:47], v[72:75]
    v_mfma_f32_16x16x32_bf16 v[76:79], v[180:183], v[44:47], v[76:79]
    v_mfma_f32_16x16x32_bf16 v[80:83], v[108:111], v[48:51], v[80:83]
    v_mfma_f32_16x16x32_bf16 v[84:87], v[180:183], v[48:51], v[84:87]
    v_mfma_f32_16x16x32_bf16 v[88:91], v[108:111], v[52:55], v[88:91]
    v_mfma_f32_16x16x32_bf16 v[92:95], v[180:183], v[52:55], v[92:95]
    ds_read_b128 v[36:39], v6 offset:5120
    ds_read_b128 v[40:43], v6 offset:23552
    ds_read_b128 v[44:47], v6 offset:41984
    ds_read_b128 v[48:51], v15 offset:5120
    ds_read_b128 v[52:55], v15 offset:23552
    s_add_u32 s24, s24, 4096
    buffer_load_dwordx4 v[128:131], v6, s[20:23], s24 offen offset:0
    s_add_u32 s25, s25, 4096
    buffer_load_dwordx4 v[200:203], v6, s[20:23], s25 offen offset:0
    s_waitcnt vmcnt(13) lgkmcnt(5)
    v_mfma_f32_16x16x32_bf16 v[56:59], v[112:115], v[16:19], v[56:59]
    v_mfma_f32_16x16x32_bf16 v[60:63], v[184:187], v[16:19], v[60:63]
    v_mfma_f32_16x16x32_bf16 v[64:67], v[112:115], v[20:23], v[64:67]
    v_mfma_f32_16x16x32_bf16 v[68:71], v[184:187], v[20:23], v[68:71]
    v_mfma_f32_16x16x32_bf16 v[72:75], v[112:115], v[24:27], v[72:75]
    v_mfma_f32_16x16x32_bf16 v[76:79], v[184:187], v[24:27], v[76:79]
    v_mfma_f32_16x16x32_bf16 v[80:83], v[112:115], v[28:31], v[80:83]
    v_mfma_f32_16x16x32_bf16 v[84:87], v[184:187], v[28:31], v[84:87]
    v_mfma_f32_16x16x32_bf16 v[88:91], v[112:115], v[32:35], v[88:91]
    v_mfma_f32_16x16x32_bf16 v[92:95], v[184:187], v[32:35], v[92:95]
    s_waitcnt vmcnt(17)
    s_barrier
    ds_read_b128 v[16:19], v6 offset:6144
    ds_read_b128 v[20:23], v6 offset:24576
    ds_read_b128 v[24:27], v6 offset:43008
    ds_read_b128 v[28:31], v15 offset:6144
    ds_read_b128 v[32:35], v15 offset:24576
    buffer_load_dwordx4 v[132:135], v6, s[20:23], s24 offen offset:1024
    buffer_load_dwordx4 v[204:207], v6, s[20:23], s25 offen offset:1024
    s_waitcnt vmcnt(10) lgkmcnt(5)
    v_mfma_f32_16x16x32_bf16 v[56:59], v[116:119], v[36:39], v[56:59]
    v_mfma_f32_16x16x32_bf16 v[60:63], v[188:191], v[36:39], v[60:63]
    v_mfma_f32_16x16x32_bf16 v[64:67], v[116:119], v[40:43], v[64:67]
    v_mfma_f32_16x16x32_bf16 v[68:71], v[188:191], v[40:43], v[68:71]
    v_mfma_f32_16x16x32_bf16 v[72:75], v[116:119], v[44:47], v[72:75]
    v_mfma_f32_16x16x32_bf16 v[76:79], v[188:191], v[44:47], v[76:79]
    v_mfma_f32_16x16x32_bf16 v[80:83], v[116:119], v[48:51], v[80:83]
    v_mfma_f32_16x16x32_bf16 v[84:87], v[188:191], v[48:51], v[84:87]
    v_mfma_f32_16x16x32_bf16 v[88:91], v[116:119], v[52:55], v[88:91]
    v_mfma_f32_16x16x32_bf16 v[92:95], v[188:191], v[52:55], v[92:95]
    ds_read_b128 v[36:39], v6 offset:7168
    ds_read_b128 v[40:43], v6 offset:25600
    ds_read_b128 v[44:47], v6 offset:44032
    ds_read_b128 v[48:51], v15 offset:7168
    ds_read_b128 v[52:55], v15 offset:25600
    buffer_load_dwordx4 v[136:139], v6, s[20:23], s24 offen offset:2048
    buffer_load_dwordx4 v[208:211], v6, s[20:23], s25 offen offset:2048
    s_waitcnt vmcnt(10) lgkmcnt(5)
    v_mfma_f32_16x16x32_bf16 v[56:59], v[120:123], v[16:19], v[56:59]
    v_mfma_f32_16x16x32_bf16 v[60:63], v[192:195], v[16:19], v[60:63]
    v_mfma_f32_16x16x32_bf16 v[64:67], v[120:123], v[20:23], v[64:67]
    v_mfma_f32_16x16x32_bf16 v[68:71], v[192:195], v[20:23], v[68:71]
    v_mfma_f32_16x16x32_bf16 v[72:75], v[120:123], v[24:27], v[72:75]
    v_mfma_f32_16x16x32_bf16 v[76:79], v[192:195], v[24:27], v[76:79]
    v_mfma_f32_16x16x32_bf16 v[80:83], v[120:123], v[28:31], v[80:83]
    v_mfma_f32_16x16x32_bf16 v[84:87], v[192:195], v[28:31], v[84:87]
    v_mfma_f32_16x16x32_bf16 v[88:91], v[120:123], v[32:35], v[88:91]
    v_mfma_f32_16x16x32_bf16 v[92:95], v[192:195], v[32:35], v[92:95]
    ds_read_b128 v[16:19], v6 offset:8192
    ds_read_b128 v[20:23], v6 offset:26624
    ds_read_b128 v[24:27], v6 offset:45056
    ds_read_b128 v[28:31], v15 offset:8192
    ds_read_b128 v[32:35], v15 offset:26624
    buffer_load_dwordx4 v[140:143], v6, s[20:23], s24 offen offset:3072
    buffer_load_dwordx4 v[212:215], v6, s[20:23], s25 offen offset:3072
    s_waitcnt vmcnt(8) lgkmcnt(5)
    v_mfma_f32_16x16x32_bf16 v[56:59], v[124:127], v[36:39], v[56:59]
    v_mfma_f32_16x16x32_bf16 v[60:63], v[196:199], v[36:39], v[60:63]
    v_mfma_f32_16x16x32_bf16 v[64:67], v[124:127], v[40:43], v[64:67]
    v_mfma_f32_16x16x32_bf16 v[68:71], v[196:199], v[40:43], v[68:71]
    v_mfma_f32_16x16x32_bf16 v[72:75], v[124:127], v[44:47], v[72:75]
    v_mfma_f32_16x16x32_bf16 v[76:79], v[196:199], v[44:47], v[76:79]
    v_mfma_f32_16x16x32_bf16 v[80:83], v[124:127], v[48:51], v[80:83]
    v_mfma_f32_16x16x32_bf16 v[84:87], v[196:199], v[48:51], v[84:87]
    v_mfma_f32_16x16x32_bf16 v[88:91], v[124:127], v[52:55], v[88:91]
    v_mfma_f32_16x16x32_bf16 v[92:95], v[196:199], v[52:55], v[92:95]
    ds_read_b128 v[36:39], v6 offset:9216
    ds_read_b128 v[40:43], v6 offset:27648
    ds_read_b128 v[44:47], v6 offset:46080
    ds_read_b128 v[48:51], v15 offset:9216
    ds_read_b128 v[52:55], v15 offset:27648
    s_add_u32 s24, s24, 4096
    buffer_load_dwordx4 v[144:147], v6, s[20:23], s24 offen offset:0
    s_add_u32 s25, s25, 4096
    buffer_load_dwordx4 v[216:219], v6, s[20:23], s25 offen offset:0
    s_waitcnt vmcnt(8) lgkmcnt(5)
    v_mfma_f32_16x16x32_bf16 v[56:59], v[128:131], v[16:19], v[56:59]
    v_mfma_f32_16x16x32_bf16 v[60:63], v[200:203], v[16:19], v[60:63]
    v_mfma_f32_16x16x32_bf16 v[64:67], v[128:131], v[20:23], v[64:67]
    v_mfma_f32_16x16x32_bf16 v[68:71], v[200:203], v[20:23], v[68:71]
    v_mfma_f32_16x16x32_bf16 v[72:75], v[128:131], v[24:27], v[72:75]
    v_mfma_f32_16x16x32_bf16 v[76:79], v[200:203], v[24:27], v[76:79]
    v_mfma_f32_16x16x32_bf16 v[80:83], v[128:131], v[28:31], v[80:83]
    v_mfma_f32_16x16x32_bf16 v[84:87], v[200:203], v[28:31], v[84:87]
    v_mfma_f32_16x16x32_bf16 v[88:91], v[128:131], v[32:35], v[88:91]
    v_mfma_f32_16x16x32_bf16 v[92:95], v[200:203], v[32:35], v[92:95]
    ds_read_b128 v[16:19], v6 offset:10240
    ds_read_b128 v[20:23], v6 offset:28672
    ds_read_b128 v[24:27], v6 offset:47104
    ds_read_b128 v[28:31], v15 offset:10240
    ds_read_b128 v[32:35], v15 offset:28672
    buffer_load_dwordx4 v[148:151], v6, s[20:23], s24 offen offset:1024
    buffer_load_dwordx4 v[220:223], v6, s[20:23], s25 offen offset:1024
    s_waitcnt vmcnt(8) lgkmcnt(5)
    v_mfma_f32_16x16x32_bf16 v[56:59], v[132:135], v[36:39], v[56:59]
    v_mfma_f32_16x16x32_bf16 v[60:63], v[204:207], v[36:39], v[60:63]
    v_mfma_f32_16x16x32_bf16 v[64:67], v[132:135], v[40:43], v[64:67]
    v_mfma_f32_16x16x32_bf16 v[68:71], v[204:207], v[40:43], v[68:71]
    v_mfma_f32_16x16x32_bf16 v[72:75], v[132:135], v[44:47], v[72:75]
    v_mfma_f32_16x16x32_bf16 v[76:79], v[204:207], v[44:47], v[76:79]
    v_mfma_f32_16x16x32_bf16 v[80:83], v[132:135], v[48:51], v[80:83]
    v_mfma_f32_16x16x32_bf16 v[84:87], v[204:207], v[48:51], v[84:87]
    v_mfma_f32_16x16x32_bf16 v[88:91], v[132:135], v[52:55], v[88:91]
    v_mfma_f32_16x16x32_bf16 v[92:95], v[204:207], v[52:55], v[92:95]
    ds_read_b128 v[36:39], v6 offset:11264
    ds_read_b128 v[40:43], v6 offset:29696
    ds_read_b128 v[44:47], v6 offset:48128
    ds_read_b128 v[48:51], v15 offset:11264
    ds_read_b128 v[52:55], v15 offset:29696
    s_waitcnt vmcnt(14)
    v_add_f32 v240, v240, v248
    v_add_f32 v241, v241, v249
    v_add_f32 v242, v242, v250
    v_add_f32 v243, v243, v251
    v_add_f32 v244, v244, v252
    v_add_f32 v245, v245, v253
    v_add_f32 v246, v246, v254
    v_add_f32 v247, v247, v255
    buffer_load_dwordx4 v[248:251], v12, s[20:23], s29 offen
    buffer_load_dwordx4 v[252:255], v12, s[20:23], s29 offen offset:64
    buffer_load_dwordx4 v[152:155], v6, s[20:23], s24 offen offset:2048
    buffer_load_dwordx4 v[224:227], v6, s[20:23], s25 offen offset:2048
    s_waitcnt vmcnt(10) lgkmcnt(5)
    v_mfma_f32_16x16x32_bf16 v[56:59], v[136:139], v[16:19], v[56:59]
    v_mfma_f32_16x16x32_bf16 v[60:63], v[208:211], v[16:19], v[60:63]
    v_mfma_f32_16x16x32_bf16 v[64:67], v[136:139], v[20:23], v[64:67]
    v_mfma_f32_16x16x32_bf16 v[68:71], v[208:211], v[20:23], v[68:71]
    v_mfma_f32_16x16x32_bf16 v[72:75], v[136:139], v[24:27], v[72:75]
    v_mfma_f32_16x16x32_bf16 v[76:79], v[208:211], v[24:27], v[76:79]
    v_mfma_f32_16x16x32_bf16 v[80:83], v[136:139], v[28:31], v[80:83]
    v_mfma_f32_16x16x32_bf16 v[84:87], v[208:211], v[28:31], v[84:87]
    v_mfma_f32_16x16x32_bf16 v[88:91], v[136:139], v[32:35], v[88:91]
    v_mfma_f32_16x16x32_bf16 v[92:95], v[208:211], v[32:35], v[92:95]
    s_waitcnt vmcnt(24)
    s_barrier
    ds_read_b128 v[16:19], v6 offset:12288
    ds_read_b128 v[20:23], v6 offset:30720
    ds_read_b128 v[24:27], v6 offset:49152
    ds_read_b128 v[28:31], v15 offset:12288
    ds_read_b128 v[32:35], v15 offset:30720
    buffer_load_dwordx4 v[156:159], v6, s[20:23], s24 offen offset:3072
    buffer_load_dwordx4 v[228:231], v6, s[20:23], s25 offen offset:3072
    s_waitcnt vmcnt(10) lgkmcnt(5)
    v_mfma_f32_16x16x32_bf16 v[56:59], v[140:143], v[36:39], v[56:59]
    v_mfma_f32_16x16x32_bf16 v[60:63], v[212:215], v[36:39], v[60:63]
    v_mfma_f32_16x16x32_bf16 v[64:67], v[140:143], v[40:43], v[64:67]
    v_mfma_f32_16x16x32_bf16 v[68:71], v[212:215], v[40:43], v[68:71]
    v_mfma_f32_16x16x32_bf16 v[72:75], v[140:143], v[44:47], v[72:75]
    v_mfma_f32_16x16x32_bf16 v[76:79], v[212:215], v[44:47], v[76:79]
    v_mfma_f32_16x16x32_bf16 v[80:83], v[140:143], v[48:51], v[80:83]
    v_mfma_f32_16x16x32_bf16 v[84:87], v[212:215], v[48:51], v[84:87]
    v_mfma_f32_16x16x32_bf16 v[88:91], v[140:143], v[52:55], v[88:91]
    v_mfma_f32_16x16x32_bf16 v[92:95], v[212:215], v[52:55], v[92:95]
    ds_read_b128 v[36:39], v6 offset:13312
    ds_read_b128 v[40:43], v6 offset:31744
    ds_read_b128 v[44:47], v6 offset:50176
    ds_read_b128 v[48:51], v15 offset:13312
    ds_read_b128 v[52:55], v15 offset:31744
    s_add_u32 s24, s24, 4096
    buffer_load_dwordx4 v[160:163], v6, s[20:23], s24 offen offset:0
    s_add_u32 s25, s25, 4096
    buffer_load_dwordx4 v[232:235], v6, s[20:23], s25 offen offset:0
    s_waitcnt vmcnt(10) lgkmcnt(5)
    v_mfma_f32_16x16x32_bf16 v[56:59], v[144:147], v[16:19], v[56:59]
    v_mfma_f32_16x16x32_bf16 v[60:63], v[216:219], v[16:19], v[60:63]
    v_mfma_f32_16x16x32_bf16 v[64:67], v[144:147], v[20:23], v[64:67]
    v_mfma_f32_16x16x32_bf16 v[68:71], v[216:219], v[20:23], v[68:71]
    v_mfma_f32_16x16x32_bf16 v[72:75], v[144:147], v[24:27], v[72:75]
    v_mfma_f32_16x16x32_bf16 v[76:79], v[216:219], v[24:27], v[76:79]
    v_mfma_f32_16x16x32_bf16 v[80:83], v[144:147], v[28:31], v[80:83]
    v_mfma_f32_16x16x32_bf16 v[84:87], v[216:219], v[28:31], v[84:87]
    v_mfma_f32_16x16x32_bf16 v[88:91], v[144:147], v[32:35], v[88:91]
    v_mfma_f32_16x16x32_bf16 v[92:95], v[216:219], v[32:35], v[92:95]
    ds_read_b128 v[16:19], v6 offset:14336
    ds_read_b128 v[20:23], v6 offset:32768
    ds_read_b128 v[24:27], v6 offset:51200
    ds_read_b128 v[28:31], v15 offset:14336
    ds_read_b128 v[32:35], v15 offset:32768
    buffer_load_dwordx4 v[164:167], v6, s[20:23], s24 offen offset:1024
    buffer_load_dwordx4 v[236:239], v6, s[20:23], s25 offen offset:1024
    s_waitcnt vmcnt(10) lgkmcnt(5)
    v_mfma_f32_16x16x32_bf16 v[56:59], v[148:151], v[36:39], v[56:59]
    v_mfma_f32_16x16x32_bf16 v[60:63], v[220:223], v[36:39], v[60:63]
    v_mfma_f32_16x16x32_bf16 v[64:67], v[148:151], v[40:43], v[64:67]
    v_mfma_f32_16x16x32_bf16 v[68:71], v[220:223], v[40:43], v[68:71]
    v_mfma_f32_16x16x32_bf16 v[72:75], v[148:151], v[44:47], v[72:75]
    v_mfma_f32_16x16x32_bf16 v[76:79], v[220:223], v[44:47], v[76:79]
    v_mfma_f32_16x16x32_bf16 v[80:83], v[148:151], v[48:51], v[80:83]
    v_mfma_f32_16x16x32_bf16 v[84:87], v[220:223], v[48:51], v[84:87]
    v_mfma_f32_16x16x32_bf16 v[88:91], v[148:151], v[52:55], v[88:91]
    v_mfma_f32_16x16x32_bf16 v[92:95], v[220:223], v[52:55], v[92:95]
    ds_read_b128 v[36:39], v6 offset:15360
    ds_read_b128 v[40:43], v6 offset:33792
    ds_read_b128 v[44:47], v6 offset:52224
    ds_read_b128 v[48:51], v15 offset:15360
    ds_read_b128 v[52:55], v15 offset:33792
    s_waitcnt vmcnt(6) lgkmcnt(5)
    v_mfma_f32_16x16x32_bf16 v[56:59], v[152:155], v[16:19], v[56:59]
    v_mfma_f32_16x16x32_bf16 v[60:63], v[224:227], v[16:19], v[60:63]
    v_mfma_f32_16x16x32_bf16 v[64:67], v[152:155], v[20:23], v[64:67]
    v_mfma_f32_16x16x32_bf16 v[68:71], v[224:227], v[20:23], v[68:71]
    v_mfma_f32_16x16x32_bf16 v[72:75], v[152:155], v[24:27], v[72:75]
    v_mfma_f32_16x16x32_bf16 v[76:79], v[224:227], v[24:27], v[76:79]
    v_mfma_f32_16x16x32_bf16 v[80:83], v[152:155], v[28:31], v[80:83]
    v_mfma_f32_16x16x32_bf16 v[84:87], v[224:227], v[28:31], v[84:87]
    v_mfma_f32_16x16x32_bf16 v[88:91], v[152:155], v[32:35], v[88:91]
    v_mfma_f32_16x16x32_bf16 v[92:95], v[224:227], v[32:35], v[92:95]
    ds_read_b128 v[16:19], v6 offset:16384
    ds_read_b128 v[20:23], v6 offset:34816
    ds_read_b128 v[24:27], v6 offset:53248
    ds_read_b128 v[28:31], v15 offset:16384
    ds_read_b128 v[32:35], v15 offset:34816
    s_waitcnt vmcnt(4) lgkmcnt(5)
    v_mfma_f32_16x16x32_bf16 v[56:59], v[156:159], v[36:39], v[56:59]
    v_mfma_f32_16x16x32_bf16 v[60:63], v[228:231], v[36:39], v[60:63]
    v_mfma_f32_16x16x32_bf16 v[64:67], v[156:159], v[40:43], v[64:67]
    v_mfma_f32_16x16x32_bf16 v[68:71], v[228:231], v[40:43], v[68:71]
    v_mfma_f32_16x16x32_bf16 v[72:75], v[156:159], v[44:47], v[72:75]
    v_mfma_f32_16x16x32_bf16 v[76:79], v[228:231], v[44:47], v[76:79]
    v_mfma_f32_16x16x32_bf16 v[80:83], v[156:159], v[48:51], v[80:83]
    v_mfma_f32_16x16x32_bf16 v[84:87], v[228:231], v[48:51], v[84:87]
    v_mfma_f32_16x16x32_bf16 v[88:91], v[156:159], v[52:55], v[88:91]
    v_mfma_f32_16x16x32_bf16 v[92:95], v[228:231], v[52:55], v[92:95]
    ds_read_b128 v[36:39], v6 offset:17408
    ds_read_b128 v[40:43], v6 offset:35840
    ds_read_b128 v[44:47], v6 offset:54272
    ds_read_b128 v[48:51], v15 offset:17408
    ds_read_b128 v[52:55], v15 offset:35840
    s_waitcnt vmcnt(2) lgkmcnt(5)
    v_mfma_f32_16x16x32_bf16 v[56:59], v[160:163], v[16:19], v[56:59]
    v_mfma_f32_16x16x32_bf16 v[60:63], v[232:235], v[16:19], v[60:63]
    v_mfma_f32_16x16x32_bf16 v[64:67], v[160:163], v[20:23], v[64:67]
    v_mfma_f32_16x16x32_bf16 v[68:71], v[232:235], v[20:23], v[68:71]
    v_mfma_f32_16x16x32_bf16 v[72:75], v[160:163], v[24:27], v[72:75]
    v_mfma_f32_16x16x32_bf16 v[76:79], v[232:235], v[24:27], v[76:79]
    v_mfma_f32_16x16x32_bf16 v[80:83], v[160:163], v[28:31], v[80:83]
    v_mfma_f32_16x16x32_bf16 v[84:87], v[232:235], v[28:31], v[84:87]
    v_mfma_f32_16x16x32_bf16 v[88:91], v[160:163], v[32:35], v[88:91]
    v_mfma_f32_16x16x32_bf16 v[92:95], v[232:235], v[32:35], v[92:95]
    s_waitcnt vmcnt(0) lgkmcnt(0)
    v_mfma_f32_16x16x32_bf16 v[56:59], v[164:167], v[36:39], v[56:59]
    v_mfma_f32_16x16x32_bf16 v[60:63], v[236:239], v[36:39], v[60:63]
    v_mfma_f32_16x16x32_bf16 v[64:67], v[164:167], v[40:43], v[64:67]
    v_mfma_f32_16x16x32_bf16 v[68:71], v[236:239], v[40:43], v[68:71]
    v_mfma_f32_16x16x32_bf16 v[72:75], v[164:167], v[44:47], v[72:75]
    v_mfma_f32_16x16x32_bf16 v[76:79], v[236:239], v[44:47], v[76:79]
    v_mfma_f32_16x16x32_bf16 v[80:83], v[164:167], v[48:51], v[80:83]
    v_mfma_f32_16x16x32_bf16 v[84:87], v[236:239], v[48:51], v[84:87]
    v_mfma_f32_16x16x32_bf16 v[88:91], v[164:167], v[52:55], v[88:91]
    v_mfma_f32_16x16x32_bf16 v[92:95], v[236:239], v[52:55], v[92:95]
    v_lshlrev_b32 v11, 3, v7
    v_add_u32 v11, 92160, v11
    ds_read_b64 v[16:17], v11 offset:0
    ds_read_b64 v[18:19], v11 offset:128
    ds_read_b64 v[20:21], v11 offset:256
    ds_read_b64 v[22:23], v11 offset:384
    ds_read_b64 v[24:25], v11 offset:512
    s_waitcnt vmcnt(0) lgkmcnt(0)
    s_nop 3
    s_barrier
    v_add_f32 v240, v240, v248
    v_add_f32 v241, v241, v249
    v_add_f32 v242, v242, v250
    v_add_f32 v243, v243, v251
    v_add_f32 v244, v244, v252
    v_add_f32 v245, v245, v253
    v_add_f32 v246, v246, v254
    v_add_f32 v247, v247, v255
    v_mul_u32_u24 v9, 480, v7
    v_lshl_add_u32 v9, v8, 3, v9
    s_lshl_b32 s24, s14, 6
    v_add_u32 v9, s24, v9
    v_fma_f32 v56, -v17, v240, v56
    v_mul_f32 v56, v16, v56
    v_fma_f32 v57, -v17, v241, v57
    v_mul_f32 v57, v16, v57
    v_fma_f32 v58, -v17, v242, v58
    v_mul_f32 v58, v16, v58
    v_fma_f32 v59, -v17, v243, v59
    v_mul_f32 v59, v16, v59
    v_cvt_pk_bf16_f32 v248, v56, v57
    v_cvt_pk_bf16_f32 v249, v58, v59
    ds_write_b64 v9, v[248:249] offset:0
    s_cmp_eq_u32 s14, 7
    s_cbranch_scc1 qkvb1_skipw0
    v_fma_f32 v60, -v17, v244, v60
    v_mul_f32 v60, v16, v60
    v_fma_f32 v61, -v17, v245, v61
    v_mul_f32 v61, v16, v61
    v_fma_f32 v62, -v17, v246, v62
    v_mul_f32 v62, v16, v62
    v_fma_f32 v63, -v17, v247, v63
    v_mul_f32 v63, v16, v63
    v_cvt_pk_bf16_f32 v248, v60, v61
    v_cvt_pk_bf16_f32 v249, v62, v63
    ds_write_b64 v9, v[248:249] offset:32
qkvb1_skipw0:
    v_fma_f32 v64, -v19, v240, v64
    v_mul_f32 v64, v18, v64
    v_fma_f32 v65, -v19, v241, v65
    v_mul_f32 v65, v18, v65
    v_fma_f32 v66, -v19, v242, v66
    v_mul_f32 v66, v18, v66
    v_fma_f32 v67, -v19, v243, v67
    v_mul_f32 v67, v18, v67
    v_cvt_pk_bf16_f32 v248, v64, v65
    v_cvt_pk_bf16_f32 v249, v66, v67
    ds_write_b64 v9, v[248:249] offset:7680
    s_cmp_eq_u32 s14, 7
    s_cbranch_scc1 qkvb1_skipw1
    v_fma_f32 v68, -v19, v244, v68
    v_mul_f32 v68, v18, v68
    v_fma_f32 v69, -v19, v245, v69
    v_mul_f32 v69, v18, v69
    v_fma_f32 v70, -v19, v246, v70
    v_mul_f32 v70, v18, v70
    v_fma_f32 v71, -v19, v247, v71
    v_mul_f32 v71, v18, v71
    v_cvt_pk_bf16_f32 v248, v68, v69
    v_cvt_pk_bf16_f32 v249, v70, v71
    ds_write_b64 v9, v[248:249] offset:7712
qkvb1_skipw1:
    v_fma_f32 v72, -v21, v240, v72
    v_mul_f32 v72, v20, v72
    v_fma_f32 v73, -v21, v241, v73
    v_mul_f32 v73, v20, v73
    v_fma_f32 v74, -v21, v242, v74
    v_mul_f32 v74, v20, v74
    v_fma_f32 v75, -v21, v243, v75
    v_mul_f32 v75, v20, v75
    v_cvt_pk_bf16_f32 v248, v72, v73
    v_cvt_pk_bf16_f32 v249, v74, v75
    ds_write_b64 v9, v[248:249] offset:15360
    s_cmp_eq_u32 s14, 7
    s_cbranch_scc1 qkvb1_skipw2
    v_fma_f32 v76, -v21, v244, v76
    v_mul_f32 v76, v20, v76
    v_fma_f32 v77, -v21, v245, v77
    v_mul_f32 v77, v20, v77
    v_fma_f32 v78, -v21, v246, v78
    v_mul_f32 v78, v20, v78
    v_fma_f32 v79, -v21, v247, v79
    v_mul_f32 v79, v20, v79
    v_cvt_pk_bf16_f32 v248, v76, v77
    v_cvt_pk_bf16_f32 v249, v78, v79
    ds_write_b64 v9, v[248:249] offset:15392
qkvb1_skipw2:
    v_fma_f32 v80, -v23, v240, v80
    v_mul_f32 v80, v22, v80
    v_fma_f32 v81, -v23, v241, v81
    v_mul_f32 v81, v22, v81
    v_fma_f32 v82, -v23, v242, v82
    v_mul_f32 v82, v22, v82
    v_fma_f32 v83, -v23, v243, v83
    v_mul_f32 v83, v22, v83
    v_cvt_pk_bf16_f32 v248, v80, v81
    v_cvt_pk_bf16_f32 v249, v82, v83
    ds_write_b64 v9, v[248:249] offset:23040
    s_cmp_eq_u32 s14, 7
    s_cbranch_scc1 qkvb1_skipw3
    v_fma_f32 v84, -v23, v244, v84
    v_mul_f32 v84, v22, v84
    v_fma_f32 v85, -v23, v245, v85
    v_mul_f32 v85, v22, v85
    v_fma_f32 v86, -v23, v246, v86
    v_mul_f32 v86, v22, v86
    v_fma_f32 v87, -v23, v247, v87
    v_mul_f32 v87, v22, v87
    v_cvt_pk_bf16_f32 v248, v84, v85
    v_cvt_pk_bf16_f32 v249, v86, v87
    ds_write_b64 v9, v[248:249] offset:23072
qkvb1_skipw3:
    v_fma_f32 v88, -v25, v240, v88
    v_mul_f32 v88, v24, v88
    v_fma_f32 v89, -v25, v241, v89
    v_mul_f32 v89, v24, v89
    v_fma_f32 v90, -v25, v242, v90
    v_mul_f32 v90, v24, v90
    v_fma_f32 v91, -v25, v243, v91
    v_mul_f32 v91, v24, v91
    v_cvt_pk_bf16_f32 v248, v88, v89
    v_cvt_pk_bf16_f32 v249, v90, v91
    ds_write_b64 v9, v[248:249] offset:30720
    s_cmp_eq_u32 s14, 7
    s_cbranch_scc1 qkvb1_skipw4
    v_fma_f32 v92, -v25, v244, v92
    v_mul_f32 v92, v24, v92
    v_fma_f32 v93, -v25, v245, v93
    v_mul_f32 v93, v24, v93
    v_fma_f32 v94, -v25, v246, v94
    v_mul_f32 v94, v24, v94
    v_fma_f32 v95, -v25, v247, v95
    v_mul_f32 v95, v24, v95
    v_cvt_pk_bf16_f32 v248, v92, v93
    v_cvt_pk_bf16_f32 v249, v94, v95
    ds_write_b64 v9, v[248:249] offset:30752
qkvb1_skipw4:
    s_waitcnt lgkmcnt(0)
    s_barrier
    v_and_b32 v3, 1, v2
    v_bfe_u32 v4, v2, 1, 2
    v_lshrrev_b32 v9, 3, v2
    s_lshl_b32 s24, s14, 3
    v_add_u32 v9, s24, v9
    v_mul_u32_u24 v11, 40, v4
    v_add_u32 v10, 16, v9
    v_mul_u32_u24 v10, 480, v10
    v_add_u32 v10, v10, v11
    v_lshlrev_b32 v13, 3, v3
    v_sub_u32 v14, v9, v13
    v_add_u32 v14, 10, v14
    v_mul_u32_u24 v14, 480, v14
    v_add_u32 v14, v14, v11
    s_lshl_b32 s24, s12, 6
    v_add_u32 v9, s24, v9
    v_sub_u32 v13, v9, v13
    ds_read_b64 v[16:17], v10 offset:0
    ds_read_b64 v[18:19], v10 offset:8
    ds_read_b64 v[20:21], v10 offset:16
    ds_read_b64 v[22:23], v10 offset:24
    ds_read_b64 v[24:25], v10 offset:32
    ds_read_b64 v[96:97], v14 offset:3040
    ds_read_b64 v[98:99], v14 offset:3048
    ds_read_b64 v[100:101], v14 offset:3056
    ds_read_b64 v[102:103], v14 offset:3064
    ds_read_b64 v[104:105], v14 offset:3072
    ds_read_b64 v[106:107], v14 offset:2080
    ds_read_b64 v[108:109], v14 offset:2088
    ds_read_b64 v[110:111], v14 offset:2096
    ds_read_b64 v[112:113], v14 offset:2104
    ds_read_b64 v[114:115], v14 offset:2112
    s_waitcnt lgkmcnt(5)
    ds_read_b64 v[116:117], v14 offset:1120
    ds_read_b64 v[118:119], v14 offset:1128
    ds_read_b64 v[120:121], v14 offset:1136
    ds_read_b64 v[122:123], v14 offset:1144
    ds_read_b64 v[124:125], v14 offset:1152
    ds_read_b64 v[126:127], v14 offset:160
    ds_read_b64 v[128:129], v14 offset:168
    ds_read_b64 v[130:131], v14 offset:176
    ds_read_b64 v[132:133], v14 offset:184
    ds_read_b64 v[134:135], v14 offset:192
    s_waitcnt lgkmcnt(5)
    ds_read_b64 v[136:137], v14 offset:3200
    ds_read_b64 v[138:139], v14 offset:3208
    ds_read_b64 v[140:141], v14 offset:3216
    ds_read_b64 v[142:143], v14 offset:3224
    ds_read_b64 v[144:145], v14 offset:3232
    ds_read_b64 v[146:147], v14 offset:2240
    ds_read_b64 v[148:149], v14 offset:2248
    ds_read_b64 v[150:151], v14 offset:2256
    ds_read_b64 v[152:153], v14 offset:2264
    ds_read_b64 v[154:155], v14 offset:2272
    s_waitcnt lgkmcnt(10)
    ds_read_b64 v[156:157], v14 offset:1280
    ds_read_b64 v[158:159], v14 offset:1288
    ds_read_b64 v[160:161], v14 offset:1296
    ds_read_b64 v[162:163], v14 offset:1304
    ds_read_b64 v[164:165], v14 offset:1312
    ds_read_b64 v[166:167], v14 offset:320
    ds_read_b64 v[168:169], v14 offset:328
    ds_read_b64 v[170:171], v14 offset:336
    ds_read_b64 v[172:173], v14 offset:344
    ds_read_b64 v[174:175], v14 offset:352
    v_mov_b32 v32, 0
    v_mov_b32 v33, 0
    v_mov_b32 v34, 0
    v_mov_b32 v35, 0
    s_waitcnt lgkmcnt(15)
    v_dot2_f32_bf16 v32, v16, v96, v32
    v_dot2_f32_bf16 v33, v16, v106, v33
    v_dot2_f32_bf16 v34, v16, v116, v34
    v_dot2_f32_bf16 v35, v16, v126, v35
    v_dot2_f32_bf16 v32, v17, v97, v32
    v_dot2_f32_bf16 v33, v17, v107, v33
    v_dot2_f32_bf16 v34, v17, v117, v34
    v_dot2_f32_bf16 v35, v17, v127, v35
    v_dot2_f32_bf16 v32, v18, v98, v32
    v_dot2_f32_bf16 v33, v18, v108, v33
    v_dot2_f32_bf16 v34, v18, v118, v34
    v_dot2_f32_bf16 v35, v18, v128, v35
    v_dot2_f32_bf16 v32, v19, v99, v32
    v_dot2_f32_bf16 v33, v19, v109, v33
    v_dot2_f32_bf16 v34, v19, v119, v34
    v_dot2_f32_bf16 v35, v19, v129, v35
    v_dot2_f32_bf16 v32, v20, v100, v32
    v_dot2_f32_bf16 v33, v20, v110, v33
    v_dot2_f32_bf16 v34, v20, v120, v34
    v_dot2_f32_bf16 v35, v20, v130, v35
    v_dot2_f32_bf16 v32, v21, v101, v32
    v_dot2_f32_bf16 v33, v21, v111, v33
    v_dot2_f32_bf16 v34, v21, v121, v34
    v_dot2_f32_bf16 v35, v21, v131, v35
    v_dot2_f32_bf16 v32, v22, v102, v32
    v_dot2_f32_bf16 v33, v22, v112, v33
    v_dot2_f32_bf16 v34, v22, v122, v34
    v_dot2_f32_bf16 v35, v22, v132, v35
    v_dot2_f32_bf16 v32, v23, v103, v32
    v_dot2_f32_bf16 v33, v23, v113, v33
    v_dot2_f32_bf16 v34, v23, v123, v34
    v_dot2_f32_bf16 v35, v23, v133, v35
    v_dot2_f32_bf16 v32, v24, v104, v32
    v_dot2_f32_bf16 v33, v24, v114, v33
    v_dot2_f32_bf16 v34, v24, v124, v34
    v_dot2_f32_bf16 v35, v24, v134, v35
    s_mov_b32 s37, 0x3eae1a93
    v_mov_b32 v12, 0xf149f2ca
    s_nop 1
    v_mul_f32 v32, s37, v32
    v_cmp_le_i32 vcc, 0, v13
    s_nop 1
    v_cndmask_b32 v32, v12, v32, vcc
    v_mul_f32 v33, s37, v33
    v_cmp_le_i32 vcc, 2, v13
    s_nop 1
    v_cndmask_b32 v33, v12, v33, vcc
    v_mul_f32 v34, s37, v34
    v_cmp_le_i32 vcc, 4, v13
    s_nop 1
    v_cndmask_b32 v34, v12, v34, vcc
    v_mul_f32 v35, s37, v35
    v_cmp_le_i32 vcc, 6, v13
    s_nop 1
    v_cndmask_b32 v35, v12, v35, vcc
    v_max3_f32 v15, v32, v33, v34
    v_max_f32 v15, v15, v35
    s_nop 1
    v_max_f32_dpp v15, v15, v15 quad_perm:[1,0,3,2] row_mask:0xf bank_mask:0xf
    v_sub_f32 v32, v32, v15
    v_sub_f32 v33, v33, v15
    v_sub_f32 v34, v34, v15
    v_sub_f32 v35, v35, v15
    v_exp_f32 v32, v32
    v_exp_f32 v33, v33
    v_exp_f32 v34, v34
    v_exp_f32 v35, v35
    s_nop 0
    v_add_f32 v15, v32, v33
    v_add_f32 v26, v34, v35
    v_add_f32 v15, v15, v26
    s_nop 1
    v_add_f32_dpp v15, v15, v15 quad_perm:[1,0,3,2] row_mask:0xf bank_mask:0xf
    v_rcp_f32 v15, v15
    s_waitcnt lgkmcnt(0)
    v_mul_f32 v32, v32, v15
    v_mul_f32 v33, v33, v15
    v_mul_f32 v34, v34, v15
    v_mul_f32 v35, v35, v15
    v_lshlrev_b32 v58, 16, v136
    v_and_b32 v59, 0xffff0000, v136
    v_mul_f32 v40, v32, v58
    v_mul_f32 v41, v32, v59
    v_lshlrev_b32 v58, 16, v146
    v_and_b32 v59, 0xffff0000, v146
    v_fmac_f32 v40, v33, v58
    v_fmac_f32 v41, v33, v59
    v_lshlrev_b32 v58, 16, v156
    v_and_b32 v59, 0xffff0000, v156
    v_fmac_f32 v40, v34, v58
    v_fmac_f32 v41, v34, v59
    v_lshlrev_b32 v58, 16, v166
    v_and_b32 v59, 0xffff0000, v166
    v_fmac_f32 v40, v35, v58
    v_fmac_f32 v41, v35, v59
    v_lshlrev_b32 v58, 16, v137
    v_and_b32 v59, 0xffff0000, v137
    v_mul_f32 v42, v32, v58
    v_mul_f32 v43, v32, v59
    v_lshlrev_b32 v58, 16, v147
    v_and_b32 v59, 0xffff0000, v147
    v_fmac_f32 v42, v33, v58
    v_fmac_f32 v43, v33, v59
    v_lshlrev_b32 v58, 16, v157
    v_and_b32 v59, 0xffff0000, v157
    v_fmac_f32 v42, v34, v58
    v_fmac_f32 v43, v34, v59
    v_lshlrev_b32 v58, 16, v167
    v_and_b32 v59, 0xffff0000, v167
    v_fmac_f32 v42, v35, v58
    v_fmac_f32 v43, v35, v59
    v_lshlrev_b32 v58, 16, v138
    v_and_b32 v59, 0xffff0000, v138
    v_mul_f32 v44, v32, v58
    v_mul_f32 v45, v32, v59
    v_lshlrev_b32 v58, 16, v148
    v_and_b32 v59, 0xffff0000, v148
    v_fmac_f32 v44, v33, v58
    v_fmac_f32 v45, v33, v59
    v_lshlrev_b32 v58, 16, v158
    v_and_b32 v59, 0xffff0000, v158
    v_fmac_f32 v44, v34, v58
    v_fmac_f32 v45, v34, v59
    v_lshlrev_b32 v58, 16, v168
    v_and_b32 v59, 0xffff0000, v168
    v_fmac_f32 v44, v35, v58
    v_fmac_f32 v45, v35, v59
    v_lshlrev_b32 v58, 16, v139
    v_and_b32 v59, 0xffff0000, v139
    v_mul_f32 v46, v32, v58
    v_mul_f32 v47, v32, v59
    v_lshlrev_b32 v58, 16, v149
    v_and_b32 v59, 0xffff0000, v149
    v_fmac_f32 v46, v33, v58
    v_fmac_f32 v47, v33, v59
    v_lshlrev_b32 v58, 16, v159
    v_and_b32 v59, 0xffff0000, v159
    v_fmac_f32 v46, v34, v58
    v_fmac_f32 v47, v34, v59
    v_lshlrev_b32 v58, 16, v169
    v_and_b32 v59, 0xffff0000, v169
    v_fmac_f32 v46, v35, v58
    v_fmac_f32 v47, v35, v59
    v_lshlrev_b32 v58, 16, v140
    v_and_b32 v59, 0xffff0000, v140
    v_mul_f32 v48, v32, v58
    v_mul_f32 v49, v32, v59
    v_lshlrev_b32 v58, 16, v150
    v_and_b32 v59, 0xffff0000, v150
    v_fmac_f32 v48, v33, v58
    v_fmac_f32 v49, v33, v59
    v_lshlrev_b32 v58, 16, v160
    v_and_b32 v59, 0xffff0000, v160
    v_fmac_f32 v48, v34, v58
    v_fmac_f32 v49, v34, v59
    v_lshlrev_b32 v58, 16, v170
    v_and_b32 v59, 0xffff0000, v170
    v_fmac_f32 v48, v35, v58
    v_fmac_f32 v49, v35, v59
    v_lshlrev_b32 v58, 16, v141
    v_and_b32 v59, 0xffff0000, v141
    v_mul_f32 v50, v32, v58
    v_mul_f32 v51, v32, v59
    v_lshlrev_b32 v58, 16, v151
    v_and_b32 v59, 0xffff0000, v151
    v_fmac_f32 v50, v33, v58
    v_fmac_f32 v51, v33, v59
    v_lshlrev_b32 v58, 16, v161
    v_and_b32 v59, 0xffff0000, v161
    v_fmac_f32 v50, v34, v58
    v_fmac_f32 v51, v34, v59
    v_lshlrev_b32 v58, 16, v171
    v_and_b32 v59, 0xffff0000, v171
    v_fmac_f32 v50, v35, v58
    v_fmac_f32 v51, v35, v59
    v_lshlrev_b32 v58, 16, v142
    v_and_b32 v59, 0xffff0000, v142
    v_mul_f32 v52, v32, v58
    v_mul_f32 v53, v32, v59
    v_lshlrev_b32 v58, 16, v152
    v_and_b32 v59, 0xffff0000, v152
    v_fmac_f32 v52, v33, v58
    v_fmac_f32 v53, v33, v59
    v_lshlrev_b32 v58, 16, v162
    v_and_b32 v59, 0xffff0000, v162
    v_fmac_f32 v52, v34, v58
    v_fmac_f32 v53, v34, v59
    v_lshlrev_b32 v58, 16, v172
    v_and_b32 v59, 0xffff0000, v172
    v_fmac_f32 v52, v35, v58
    v_fmac_f32 v53, v35, v59
    v_lshlrev_b32 v58, 16, v143
    v_and_b32 v59, 0xffff0000, v143
    v_mul_f32 v54, v32, v58
    v_mul_f32 v55, v32, v59
    v_lshlrev_b32 v58, 16, v153
    v_and_b32 v59, 0xffff0000, v153
    v_fmac_f32 v54, v33, v58
    v_fmac_f32 v55, v33, v59
    v_lshlrev_b32 v58, 16, v163
    v_and_b32 v59, 0xffff0000, v163
    v_fmac_f32 v54, v34, v58
    v_fmac_f32 v55, v34, v59
    v_lshlrev_b32 v58, 16, v173
    v_and_b32 v59, 0xffff0000, v173
    v_fmac_f32 v54, v35, v58
    v_fmac_f32 v55, v35, v59
    v_lshlrev_b32 v58, 16, v144
    v_and_b32 v59, 0xffff0000, v144
    v_mul_f32 v56, v32, v58
    v_mul_f32 v57, v32, v59
    v_lshlrev_b32 v58, 16, v154
    v_and_b32 v59, 0xffff0000, v154
    v_fmac_f32 v56, v33, v58
    v_fmac_f32 v57, v33, v59
    v_lshlrev_b32 v58, 16, v164
    v_and_b32 v59, 0xffff0000, v164
    v_fmac_f32 v56, v34, v58
    v_fmac_f32 v57, v34, v59
    v_lshlrev_b32 v58, 16, v174
    v_and_b32 v59, 0xffff0000, v174
    v_fmac_f32 v56, v35, v58
    v_fmac_f32 v57, v35, v59
    s_nop 1
    v_add_f32_dpp v40, v40, v40 quad_perm:[1,0,3,2] row_mask:0xf bank_mask:0xf
    v_add_f32_dpp v41, v41, v41 quad_perm:[1,0,3,2] row_mask:0xf bank_mask:0xf
    v_add_f32_dpp v42, v42, v42 quad_perm:[1,0,3,2] row_mask:0xf bank_mask:0xf
    v_add_f32_dpp v43, v43, v43 quad_perm:[1,0,3,2] row_mask:0xf bank_mask:0xf
    v_add_f32_dpp v44, v44, v44 quad_perm:[1,0,3,2] row_mask:0xf bank_mask:0xf
    v_add_f32_dpp v45, v45, v45 quad_perm:[1,0,3,2] row_mask:0xf bank_mask:0xf
    v_add_f32_dpp v46, v46, v46 quad_perm:[1,0,3,2] row_mask:0xf bank_mask:0xf
    v_add_f32_dpp v47, v47, v47 quad_perm:[1,0,3,2] row_mask:0xf bank_mask:0xf
    v_add_f32_dpp v48, v48, v48 quad_perm:[1,0,3,2] row_mask:0xf bank_mask:0xf
    v_add_f32_dpp v49, v49, v49 quad_perm:[1,0,3,2] row_mask:0xf bank_mask:0xf
    v_add_f32_dpp v50, v50, v50 quad_perm:[1,0,3,2] row_mask:0xf bank_mask:0xf
    v_add_f32_dpp v51, v51, v51 quad_perm:[1,0,3,2] row_mask:0xf bank_mask:0xf
    v_add_f32_dpp v52, v52, v52 quad_perm:[1,0,3,2] row_mask:0xf bank_mask:0xf
    v_add_f32_dpp v53, v53, v53 quad_perm:[1,0,3,2] row_mask:0xf bank_mask:0xf
    v_add_f32_dpp v54, v54, v54 quad_perm:[1,0,3,2] row_mask:0xf bank_mask:0xf
    v_add_f32_dpp v55, v55, v55 quad_perm:[1,0,3,2] row_mask:0xf bank_mask:0xf
    v_add_f32_dpp v56, v56, v56 quad_perm:[1,0,3,2] row_mask:0xf bank_mask:0xf
    v_add_f32_dpp v57, v57, v57 quad_perm:[1,0,3,2] row_mask:0xf bank_mask:0xf
    v_cvt_pk_bf16_f32 v60, v40, v41
    v_cvt_pk_bf16_f32 v61, v42, v43
    v_cvt_pk_bf16_f32 v62, v44, v45
    v_cvt_pk_bf16_f32 v63, v46, v47
    v_cvt_pk_bf16_f32 v64, v48, v49
    v_cvt_pk_bf16_f32 v65, v50, v51
    v_cvt_pk_bf16_f32 v66, v52, v53
    v_cvt_pk_bf16_f32 v67, v54, v55
    v_cvt_pk_bf16_f32 v68, v56, v57
    v_mul_u32_u24 v9, 1152, v9
    v_mul_u32_u24 v11, 36, v4
    v_add_u32 v9, v9, v11
    s_mul_i32 s24, s13, 144
    s_add_u32 s24, s24, 8388608
    v_cmp_eq_u32 vcc, 0, v3
    s_and_saveexec_b64 s[38:39], vcc
    buffer_store_dwordx4 v[60:63], v9, s[20:23], s24 offen
    buffer_store_dwordx4 v[64:67], v9, s[20:23], s24 offen offset:16
    buffer_store_dword v68, v9, s[20:23], s24 offen offset:32
    s_mov_b64 exec, s[38:39]
qkvb1_end:
    s_endpgm
.globl ob1_kernel
.type ob1_kernel,@function
.p2align 8
ob1_kernel:
    s_cmp_ge_u32 s2, 256
    s_cbranch_scc1 ob1_end
    s_load_dwordx2 s[4:5], s[0:1], 80
    s_load_dwordx2 s[6:7], s[0:1], 80
    s_load_dwordx2 s[8:9], s[0:1], 80
    s_load_dwordx2 s[10:11], s[0:1], 64
    s_and_b32 s12, s2, 63
    s_lshr_b32 s13, s2, 6
    v_lshrrev_b32 v1, 6, v0
    v_and_b32 v2, 63, v0
    v_and_b32 v3, 15, v2
    v_readfirstlane_b32 s14, v1
    v_lshrrev_b32 v4, 4, v2
    v_mul_u32_u24 v5, 1152, v3
    v_lshl_add_u32 v5, v4, 4, v5
    v_lshlrev_b32 v6, 4, v2
    s_mul_i32 s15, s12, 36864
    s_lshl_b32 s26, s12, 5
    s_waitcnt lgkmcnt(0)
    s_add_u32 s16, s4, 8388608
    s_addc_u32 s17, s5, 0
    s_mov_b32 s18, 2359296
    s_mov_b32 s19, 0x00020000
    s_mov_b32 s20, s6
    s_mov_b32 s21, s7
    s_mov_b32 s22, 268435456
    s_mov_b32 s23, 0x00020000
    s_mov_b32 s40, s14
    s_mul_i32 s41, s40, 57
    s_lshr_b32 s41, s41, 10
    s_mul_i32 s42, s41, 18
    s_sub_u32 s42, s40, s42
    s_lshl_b32 s42, s42, 6
    s_mul_i32 s41, s41, 18432
    s_add_u32 s42, s42, s41
    s_add_u32 s42, s42, s15
    s_lshl_b32 s43, s40, 10
    s_mov_b32 m0, s43
    s_add_u32 s40, s40, 9
    buffer_load_dwordx4 v5, s[16:19], s42 offen lds
    s_mul_i32 s41, s40, 57
    s_lshr_b32 s41, s41, 10
    s_mul_i32 s42, s41, 18
    s_sub_u32 s42, s40, s42
    s_lshl_b32 s42, s42, 6
    s_mul_i32 s41, s41, 18432
    s_add_u32 s42, s42, s41
    s_add_u32 s42, s42, s15
    s_lshl_b32 s43, s40, 10
    s_mov_b32 m0, s43
    s_add_u32 s40, s40, 9
    buffer_load_dwordx4 v5, s[16:19], s42 offen lds
    s_mul_i32 s41, s40, 57
    s_lshr_b32 s41, s41, 10
    s_mul_i32 s42, s41, 18
    s_sub_u32 s42, s40, s42
    s_lshl_b32 s42, s42, 6
    s_mul_i32 s41, s41, 18432
    s_add_u32 s42, s42, s41
    s_add_u32 s42, s42, s15
    s_lshl_b32 s43, s40, 10
    s_mov_b32 m0, s43
    s_add_u32 s40, s40, 9
    buffer_load_dwordx4 v5, s[16:19], s42 offen lds
    s_mul_i32 s41, s40, 57
    s_lshr_b32 s41, s41, 10
    s_mul_i32 s42, s41, 18
    s_sub_u32 s42, s40, s42
    s_lshl_b32 s42, s42, 6
    s_mul_i32 s41, s41, 18432
    s_add_u32 s42, s42, s41
    s_add_u32 s42, s42, s15
    s_lshl_b32 s43, s40, 10
    s_mov_b32 m0, s43
    s_add_u32 s40, s40, 9
    buffer_load_dwordx4 v5, s[16:19], s42 offen lds
ob1_dmadone:
    s_barrier
    s_mul_i32 s24, s13, 9
    s_add_u32 s24, s24, s14
    s_mul_i32 s25, s24, 18432
    s_add_u32 s25, s25, 1572864
    buffer_load_dwordx4 v[56:59], v6, s[20:23], s25 offen offset:0
    buffer_load_dwordx4 v[60:63], v6, s[20:23], s25 offen offset:1024
    buffer_load_dwordx4 v[64:67], v6, s[20:23], s25 offen offset:2048
    buffer_load_dwordx4 v[68:71], v6, s[20:23], s25 offen offset:3072
    s_add_u32 s25, s25, 4096
    buffer_load_dwordx4 v[72:75], v6, s[20:23], s25 offen offset:0
    buffer_load_dwordx4 v[76:79], v6, s[20:23], s25 offen offset:1024
    buffer_load_dwordx4 v[80:83], v6, s[20:23], s25 offen offset:2048
    buffer_load_dwordx4 v[84:87], v6, s[20:23], s25 offen offset:3072
    s_add_u32 s25, s25, 4096
    buffer_load_dwordx4 v[88:91], v6, s[20:23], s25 offen offset:0
    v_add_u32 v7, s26, v3
    s_lshl_b32 s27, s24, 4
    v_lshl_add_u32 v10, v4, 2, s27
    v_mul_u32_u24 v8, 1152, v7
    v_lshl_add_u32 v8, v10, 1, v8
    v_add_u32 v9, 18432, v8
    s_add_u32 s28, s8, 17825792
    s_addc_u32 s29, s9, 0
    s_mov_b32 s30, 2359296
    s_mov_b32 s31, 0x00020000
    s_mov_b32 s32, s10
    s_mov_b32 s33, s11
    s_mov_b32 s34, 2359296
    s_mov_b32 s35, 0x00020000
    buffer_load_dwordx2 v[148:149], v8, s[28:31], 0 offen
    buffer_load_dwordx2 v[150:151], v9, s[28:31], 0 offen
    s_waitcnt vmcnt(11)
    s_barrier
    v_mov_b32 v48, 0
    v_mov_b32 v49, 0
    v_mov_b32 v50, 0
    v_mov_b32 v51, 0
    v_mov_b32 v52, 0
    v_mov_b32 v53, 0
    v_mov_b32 v54, 0
    v_mov_b32 v55, 0
    ds_read_b128 v[16:19], v6 offset:0
    ds_read_b128 v[20:23], v6 offset:18432
    ds_read_b128 v[24:27], v6 offset:1024
    ds_read_b128 v[28:31], v6 offset:19456
    ds_read_b128 v[32:35], v6 offset:2048
    ds_read_b128 v[36:39], v6 offset:20480
    ds_read_b128 v[40:43], v6 offset:3072
    ds_read_b128 v[44:47], v6 offset:21504
    buffer_load_dwordx4 v[92:95], v6, s[20:23], s25 offen offset:1024
    s_waitcnt vmcnt(11) lgkmcnt(6)
    v_mfma_f32_16x16x32_bf16 v[48:51], v[56:59], v[16:19], v[48:51]
    v_mfma_f32_16x16x32_bf16 v[52:55], v[56:59], v[20:23], v[52:55]
    ds_read_b128 v[16:19], v6 offset:4096
    ds_read_b128 v[20:23], v6 offset:22528
    buffer_load_dwordx4 v[96:99], v6, s[20:23], s25 offen offset:2048
    s_waitcnt vmcnt(11) lgkmcnt(6)
    v_mfma_f32_16x16x32_bf16 v[48:51], v[60:63], v[24:27], v[48:51]
    v_mfma_f32_16x16x32_bf16 v[52:55], v[60:63], v[28:31], v[52:55]
    ds_read_b128 v[24:27], v6 offset:5120
    ds_read_b128 v[28:31], v6 offset:23552
    buffer_load_dwordx4 v[100:103], v6, s[20:23], s25 offen offset:3072
    s_waitcnt vmcnt(11) lgkmcnt(6)
    v_mfma_f32_16x16x32_bf16 v[48:51], v[64:67], v[32:35], v[48:51]
    v_mfma_f32_16x16x32_bf16 v[52:55], v[64:67], v[36:39], v[52:55]
    ds_read_b128 v[32:35], v6 offset:6144
    ds_read_b128 v[36:39], v6 offset:24576
    s_add_u32 s25, s25, 4096
    buffer_load_dwordx4 v[104:107], v6, s[20:23], s25 offen offset:0
    s_waitcnt vmcnt(11) lgkmcnt(6)
    v_mfma_f32_16x16x32_bf16 v[48:51], v[68:71], v[40:43], v[48:51]
    v_mfma_f32_16x16x32_bf16 v[52:55], v[68:71], v[44:47], v[52:55]
    ds_read_b128 v[40:43], v6 offset:7168
    ds_read_b128 v[44:47], v6 offset:25600
    buffer_load_dwordx4 v[108:111], v6, s[20:23], s25 offen offset:1024
    s_waitcnt vmcnt(11) lgkmcnt(6)
    v_mfma_f32_16x16x32_bf16 v[48:51], v[72:75], v[16:19], v[48:51]
    v_mfma_f32_16x16x32_bf16 v[52:55], v[72:75], v[20:23], v[52:55]
    ds_read_b128 v[16:19], v6 offset:8192
    ds_read_b128 v[20:23], v6 offset:26624
    buffer_load_dwordx4 v[112:115], v6, s[20:23], s25 offen offset:2048
    s_waitcnt vmcnt(11) lgkmcnt(6)
    v_mfma_f32_16x16x32_bf16 v[48:51], v[76:79], v[24:27], v[48:51]
    v_mfma_f32_16x16x32_bf16 v[52:55], v[76:79], v[28:31], v[52:55]
    ds_read_b128 v[24:27], v6 offset:9216
    ds_read_b128 v[28:31], v6 offset:27648
    buffer_load_dwordx4 v[116:119], v6, s[20:23], s25 offen offset:3072
    s_waitcnt vmcnt(11) lgkmcnt(6)
    v_mfma_f32_16x16x32_bf16 v[48:51], v[80:83], v[32:35], v[48:51]
    v_mfma_f32_16x16x32_bf16 v[52:55], v[80:83], v[36:39], v[52:55]
    ds_read_b128 v[32:35], v6 offset:10240
    ds_read_b128 v[36:39], v6 offset:28672
    s_add_u32 s25, s25, 4096
    buffer_load_dwordx4 v[120:123], v6, s[20:23], s25 offen offset:0
    s_waitcnt vmcnt(11) lgkmcnt(6)
    v_mfma_f32_16x16x32_bf16 v[48:51], v[84:87], v[40:43], v[48:51]
    v_mfma_f32_16x16x32_bf16 v[52:55], v[84:87], v[44:47], v[52:55]
    ds_read_b128 v[40:43], v6 offset:11264
    ds_read_b128 v[44:47], v6 offset:29696
    buffer_load_dwordx4 v[124:127], v6, s[20:23], s25 offen offset:1024
    s_waitcnt vmcnt(11) lgkmcnt(6)
    v_mfma_f32_16x16x32_bf16 v[48:51], v[88:91], v[16:19], v[48:51]
    v_mfma_f32_16x16x32_bf16 v[52:55], v[88:91], v[20:23], v[52:55]
    ds_read_b128 v[16:19], v6 offset:12288
    ds_read_b128 v[20:23], v6 offset:30720
    s_waitcnt vmcnt(8) lgkmcnt(6)
    v_mfma_f32_16x16x32_bf16 v[48:51], v[92:95], v[24:27], v[48:51]
    v_mfma_f32_16x16x32_bf16 v[52:55], v[92:95], v[28:31], v[52:55]
    ds_read_b128 v[24:27], v6 offset:13312
    ds_read_b128 v[28:31], v6 offset:31744
    s_waitcnt vmcnt(7) lgkmcnt(6)
    v_mfma_f32_16x16x32_bf16 v[48:51], v[96:99], v[32:35], v[48:51]
    v_mfma_f32_16x16x32_bf16 v[52:55], v[96:99], v[36:39], v[52:55]
    ds_read_b128 v[32:35], v6 offset:14336
    ds_read_b128 v[36:39], v6 offset:32768
    s_waitcnt vmcnt(6) lgkmcnt(6)
    v_mfma_f32_16x16x32_bf16 v[48:51], v[100:103], v[40:43], v[48:51]
    v_mfma_f32_16x16x32_bf16 v[52:55], v[100:103], v[44:47], v[52:55]
    ds_read_b128 v[40:43], v6 offset:15360
    ds_read_b128 v[44:47], v6 offset:33792
    s_waitcnt vmcnt(5) lgkmcnt(6)
    v_mfma_f32_16x16x32_bf16 v[48:51], v[104:107], v[16:19], v[48:51]
    v_mfma_f32_16x16x32_bf16 v[52:55], v[104:107], v[20:23], v[52:55]
    ds_read_b128 v[16:19], v6 offset:16384
    ds_read_b128 v[20:23], v6 offset:34816
    s_waitcnt vmcnt(4) lgkmcnt(6)
    v_mfma_f32_16x16x32_bf16 v[48:51], v[108:111], v[24:27], v[48:51]
    v_mfma_f32_16x16x32_bf16 v[52:55], v[108:111], v[28:31], v[52:55]
    ds_read_b128 v[24:27], v6 offset:17408
    ds_read_b128 v[28:31], v6 offset:35840
    s_waitcnt vmcnt(3) lgkmcnt(6)
    v_mfma_f32_16x16x32_bf16 v[48:51], v[112:115], v[32:35], v[48:51]
    v_mfma_f32_16x16x32_bf16 v[52:55], v[112:115], v[36:39], v[52:55]
    s_waitcnt vmcnt(2) lgkmcnt(4)
    v_mfma_f32_16x16x32_bf16 v[48:51], v[116:119], v[40:43], v[48:51]
    v_mfma_f32_16x16x32_bf16 v[52:55], v[116:119], v[44:47], v[52:55]
    s_waitcnt vmcnt(1) lgkmcnt(2)
    v_mfma_f32_16x16x32_bf16 v[48:51], v[120:123], v[16:19], v[48:51]
    v_mfma_f32_16x16x32_bf16 v[52:55], v[120:123], v[20:23], v[52:55]
    s_waitcnt vmcnt(0) lgkmcnt(0)
    v_mfma_f32_16x16x32_bf16 v[48:51], v[124:127], v[24:27], v[48:51]
    v_mfma_f32_16x16x32_bf16 v[52:55], v[124:127], v[28:31], v[52:55]
    s_waitcnt vmcnt(0)
    s_nop 7
    v_mov_b32 v159, 0x3f803f80
    v_cvt_pk_bf16_f32 v152, v48, v49
    v_cvt_pk_bf16_f32 v153, v50, v51
    v_lshlrev_b32 v154, 16, v152
    v_and_b32 v155, 0xffff0000, v152
    v_lshlrev_b32 v156, 16, v153
    v_and_b32 v157, 0xffff0000, v153
    v_lshlrev_b32 v158, 16, v148
    v_and_b32 v152, 0xffff0000, v148
    v_add_f32 v154, v154, v158
    v_add_f32 v155, v155, v152
    v_lshlrev_b32 v158, 16, v149
    v_and_b32 v152, 0xffff0000, v149
    v_add_f32 v156, v156, v158
    v_add_f32 v157, v157, v152
    v_cvt_pk_bf16_f32 v148, v154, v155
    v_cvt_pk_bf16_f32 v149, v156, v157
    buffer_store_dwordx2 v[148:149], v8, s[32:35], 0 offen
    v_cvt_pk_bf16_f32 v152, v52, v53
    v_cvt_pk_bf16_f32 v153, v54, v55
    v_lshlrev_b32 v154, 16, v152
    v_and_b32 v155, 0xffff0000, v152
    v_lshlrev_b32 v156, 16, v153
    v_and_b32 v157, 0xffff0000, v153
    v_lshlrev_b32 v158, 16, v150
    v_and_b32 v152, 0xffff0000, v150
    v_add_f32 v154, v154, v158
    v_add_f32 v155, v155, v152
    v_lshlrev_b32 v158, 16, v151
    v_and_b32 v152, 0xffff0000, v151
    v_add_f32 v156, v156, v158
    v_add_f32 v157, v157, v152
    v_cvt_pk_bf16_f32 v150, v154, v155
    v_cvt_pk_bf16_f32 v151, v156, v157
    buffer_store_dwordx2 v[150:151], v9, s[32:35], 0 offen
ob1_fin:
ob1_end:
    s_endpgm
.section .rodata,"a"
.p2align 6
.amdhsa_kernel prep_kernel
  .amdhsa_next_free_vgpr 96
  .amdhsa_next_free_sgpr 102
  .amdhsa_accum_offset 96
  .amdhsa_group_segment_fixed_size 0
  .amdhsa_kernarg_size 88
  .amdhsa_user_sgpr_count 2
  .amdhsa_user_sgpr_kernarg_segment_ptr 1
  .amdhsa_system_sgpr_workgroup_id_x 1
.end_amdhsa_kernel
.p2align 6
.amdhsa_kernel qkva0_kernel
  .amdhsa_next_free_vgpr 160
  .amdhsa_next_free_sgpr 102
  .amdhsa_accum_offset 160
  .amdhsa_group_segment_fixed_size 0
  .amdhsa_kernarg_size 88
  .amdhsa_user_sgpr_count 2
  .amdhsa_user_sgpr_kernarg_segment_ptr 1
  .amdhsa_system_sgpr_workgroup_id_x 1
.end_amdhsa_kernel
.p2align 6
.amdhsa_kernel attn_kernel
  .amdhsa_next_free_vgpr 128
  .amdhsa_next_free_sgpr 102
  .amdhsa_accum_offset 128
  .amdhsa_group_segment_fixed_size 0
  .amdhsa_kernarg_size 88
  .amdhsa_user_sgpr_count 2
  .amdhsa_user_sgpr_kernarg_segment_ptr 1
  .amdhsa_system_sgpr_workgroup_id_x 1
.end_amdhsa_kernel
.p2align 6
.amdhsa_kernel oa0_kernel
  .amdhsa_next_free_vgpr 160
  .amdhsa_next_free_sgpr 102
  .amdhsa_accum_offset 160
  .amdhsa_group_segment_fixed_size 0
  .amdhsa_kernarg_size 88
  .amdhsa_user_sgpr_count 2
  .amdhsa_user_sgpr_kernarg_segment_ptr 1
  .amdhsa_system_sgpr_workgroup_id_x 1
.end_amdhsa_kernel
.p2align 6
.amdhsa_kernel qkvb0_kernel
  .amdhsa_next_free_vgpr 256
  .amdhsa_next_free_sgpr 102
  .amdhsa_accum_offset 256
  .amdhsa_group_segment_fixed_size 0
  .amdhsa_kernarg_size 88
  .amdhsa_user_sgpr_count 2
  .amdhsa_user_sgpr_kernarg_segment_ptr 1
  .amdhsa_system_sgpr_workgroup_id_x 1
.end_amdhsa_kernel
.p2align 6
.amdhsa_kernel ob0_kernel
  .amdhsa_next_free_vgpr 160
  .amdhsa_next_free_sgpr 102
  .amdhsa_accum_offset 160
  .amdhsa_group_segment_fixed_size 0
  .amdhsa_kernarg_size 88
  .amdhsa_user_sgpr_count 2
  .amdhsa_user_sgpr_kernarg_segment_ptr 1
  .amdhsa_system_sgpr_workgroup_id_x 1
.end_amdhsa_kernel
.p2align 6
.amdhsa_kernel qkva1_kernel
  .amdhsa_next_free_vgpr 160
  .amdhsa_next_free_sgpr 102
  .amdhsa_accum_offset 160
  .amdhsa_group_segment_fixed_size 0
  .amdhsa_kernarg_size 88
  .amdhsa_user_sgpr_count 2
  .amdhsa_user_sgpr_kernarg_segment_ptr 1
  .amdhsa_system_sgpr_workgroup_id_x 1
.end_amdhsa_kernel
.p2align 6
.amdhsa_kernel oa1_kernel
  .amdhsa_next_free_vgpr 160
  .amdhsa_next_free_sgpr 102
  .amdhsa_accum_offset 160
  .amdhsa_group_segment_fixed_size 0
  .amdhsa_kernarg_size 88
  .amdhsa_user_sgpr_count 2
  .amdhsa_user_sgpr_kernarg_segment_ptr 1
  .amdhsa_system_sgpr_workgroup_id_x 1
.end_amdhsa_kernel
.p2align 6
.amdhsa_kernel qkvb1_kernel
  .amdhsa_next_free_vgpr 256
  .amdhsa_next_free_sgpr 102
  .amdhsa_accum_offset 256
  .amdhsa_group_segment_fixed_size 0
  .amdhsa_kernarg_size 88
  .amdhsa_user_sgpr_count 2
  .amdhsa_user_sgpr_kernarg_segment_ptr 1
  .amdhsa_system_sgpr_workgroup_id_x 1
.end_amdhsa_kernel
.p2align 6
.amdhsa_kernel ob1_kernel
  .amdhsa_next_free_vgpr 160
  .amdhsa_next_free_sgpr 102
  .amdhsa_accum_offset 160
  .amdhsa_group_segment_fixed_size 0
  .amdhsa_kernarg_size 88
  .amdhsa_user_sgpr_count 2
  .amdhsa_user_sgpr_kernarg_segment_ptr 1
  .amdhsa_system_sgpr_workgroup_id_x 1
.end_amdhsa_kernel
```
